```python
import torch

def _softmax(x, axis=-1):
    return torch.softmax(x, dim=axis)
def _gelu(x):
    return torch.nn.functional.gelu(x, approximate="tanh")
def _silu(x):
    return torch.nn.functional.silu(x)
def _sigmoid(x):
    return torch.sigmoid(x)
def _layernorm(x, axis=-1, eps=1e-5):
    m = x.mean(dim=axis, keepdim=True)
    v = x.var(dim=axis, keepdim=True, unbiased=False)
    return (x - m) / torch.sqrt(v + eps)
def _scatter_add(tgt, idx, src, axis=0):
    return tgt.clone().index_add_(axis, idx, src)
def _segment_sum(src, seg, n):
    out = torch.zeros((n,) + src.shape[1:], dtype=src.dtype)
    return out.index_add_(0, seg, src)
def _pad(x, pw):
    flat = tuple(v for pair in reversed(pw) for v in pair)
    return torch.nn.functional.pad(x, flat)

kernel_name = 'concat_heads__softmax_full_mha__mha_block__prompt'

def setup_inputs():

    _w = (lambda a: (lambda t: t.to(torch.bfloat16) if t.is_floating_point() else t)(torch.as_tensor(a)))
    def _A_setup():
        B, S, D = 1, 2048, 640
        return {
            "x": _w((lambda *s: torch.randn(*s, dtype=torch.bfloat16) * 0.2)(B, S, D)),
            "wqkv": _w((lambda *s: torch.randn(*s, dtype=torch.bfloat16) * 0.2)(D, 3 * D)),
            "wo": _w((lambda *s: torch.randn(*s, dtype=torch.bfloat16) * 0.05)(D, D)),
        }
    _A_in = _A_setup()

    def _B_setup():
        B, S, D, H = 1, 2048, 640, 32
        return {
            "x": _w((lambda *s: torch.randn(*s, dtype=torch.bfloat16) * 0.2)(B, S, D)),
            "wqkv": _w((lambda *s: torch.randn(*s, dtype=torch.bfloat16) * 0.2)(D, 3 * D)),
            "wo": _w((lambda *s: torch.randn(*s, dtype=torch.bfloat16) * 0.05)(D, D)),
        }
    _B_in = _B_setup()

    return {
        "A_x": _A_in["x"],
        "A_wqkv": _A_in["wqkv"],
        "A_wo": _A_in["wo"],
        "B_x": _B_in["x"],
        "B_wqkv": _B_in["wqkv"],
        "B_wo": _B_in["wo"],
    }

def reference(A_x, A_wqkv, A_wo, B_x, B_wqkv, B_wo):
    def _A_ref(x, wqkv, wo):
        B, S, D = x.shape
        H = 32; Dh = D // H
        qkv = (lambda x, *d: x.permute(*d))((x @ wqkv).reshape(B, S, 3, H, Dh), 2, 0, 3, 1, 4)
        q, k, v = qkv[0], qkv[1], qkv[2]
        scale = Dh ** -0.5
        scores = torch.einsum("bhqd,bhkd->bhqk", q, k) * scale
        p = _softmax(scores, axis=-1)
        o = torch.einsum("bhqk,bhkd->bhqd", p, v)
        return (lambda x, *d: x.permute(*d))(o, 0, 2, 1, 3).reshape(B, S, D) @ wo

    def _B_ref(x, wqkv, wo):
        B, S, D = x.shape
        H = 32
        Dh = D // H
        qkv = (lambda x, *d: x.permute(*d))((x @ wqkv).reshape(B, S, 3, H, Dh), 2, 0, 3, 1, 4)
        q, k, v = qkv[0], qkv[1], qkv[2]
        scores = torch.einsum("bhqd,bhkd->bhqk", q, k) * (Dh ** -0.5)
        p = _softmax(scores, axis=-1)
        o = torch.einsum("bhqk,bhkd->bhqd", p, v)
        return (lambda x, *d: x.permute(*d))(o, 0, 2, 1, 3).reshape(B, S, D) @ wo

    a = _A_ref(A_x, A_wqkv, A_wo)
    b = _B_ref(B_x, B_wqkv, B_wo)
    return torch.concatenate([a, b], axis=-1)
```

```asm
; @launch grid=(256,1,1) block=(512,1,1) lds=163840
.amdgcn_target "amdgcn-amd-amdhsa--gfx950"
.text
.globl concat_heads__softmax_full_mha__mha_block__prompt_kernel
.p2align 8
.type concat_heads__softmax_full_mha__mha_block__prompt_kernel,@function
concat_heads__softmax_full_mha__mha_block__prompt_kernel:
    s_cmp_ge_u32 s2, 256
    s_cbranch_scc1 L_end
    s_getpc_b64 s[56:57]
    s_load_dwordx4 s[48:51], s[0:1], 0
    s_load_dwordx4 s[52:55], s[0:1], 16
    s_load_dwordx4 s[76:79], s[0:1], 32
    s_load_dwordx4 s[80:83], s[0:1], 48
    s_load_dwordx2 s[58:59], s[0:1], 64
    v_and_b32 v1, 63, v0
    v_lshrrev_b32 v2, 6, v0
    v_and_b32 v3, 0x1ff, v0
    v_min_u32 v3, (L_code_end-concat_heads__softmax_full_mha__mha_block__prompt_kernel)/128-1, v3
    v_readfirstlane_b32 s27, v2
    v_lshlrev_b32 v3, 7, v3
    s_bfe_u32 s24, s2, 0x10002
    s_cmp_gt_u32 s27, (L_code_end-concat_heads__softmax_full_mha__mha_block__prompt_kernel)/8192
    s_cbranch_scc1 L_nocode
    global_load_dword v27, v3, s[56:57]
L_nocode:
    s_lshr_b32 s68, s2, 3
    s_bfe_u32 s36, s2, 0x10001
    s_lshl_b32 s36, s36, 3
    s_and_b32 s25, s68, 7
    s_add_u32 s25, s25, s36
    s_and_b32 s36, s2, 1
    s_lshl_b32 s36, s36, 2
    s_lshr_b32 s26, s2, 6
    s_add_u32 s26, s26, s36
    s_mul_i32 s46, s25, 80
    s_lshl_b32 s36, s36, 8
    v_add_u32 v6, s36, v1
    v_mul_u32_u24 v6, 1280, v6
    v_lshrrev_b32 v4, 4, v1
    v_and_b32 v2, 15, v1
    v_min_u32 v3, 14, v2
    v_mul_u32_u24 v5, 52, v3
    v_lshrrev_b32 v5, 8, v5
    v_mul_u32_u24 v5, 640, v5
    v_lshl_add_u32 v3, v3, 7, v5
    v_mul_u32_u24 v5, 3840, v4
    s_lshr_b32 s36, s25, 3
    s_mul_i32 s36, s36, 640
    v_add3_u32 v7, v5, v3, s36
    s_mov_b32 s6, 2621440
    s_mov_b32 s7, 0x20000
    s_mov_b32 s10, 2457600
    s_mov_b32 s11, 0x20000
    s_and_b32 s30, s68, 15
    s_lshr_b32 s31, s68, 4
    s_lshl_b32 s36, s27, 1
    s_add_u32 s31, s31, s36
    s_lshr_b32 s75, s30, 3
    s_and_b32 s30, s30, 7
    s_and_b32 s36, s25, 8
    s_add_u32 s36, s36, s30
    s_mul_i32 s36, s36, 81920
    s_lshl_b32 s37, s31, 7
    s_add_u32 s94, s36, s37
    s_and_b32 s36, s26, 4
    s_lshl_b32 s36, s36, 1
    s_add_u32 s36, s36, s30
    s_lshl_b32 s37, s31, 4
    s_add_u32 s36, s36, s37
    s_mul_i32 s36, s36, 15360
    s_cmp_eq_u32 s75, 1
    s_cselect_b32 s94, s36, s94
    s_cmp_eq_u32 s24, 0
    s_waitcnt lgkmcnt(0)
    s_cselect_b32 s4, s48, s54
    s_cselect_b32 s5, s49, s55
    s_cselect_b32 s8, s50, s76
    s_cselect_b32 s9, s51, s77
    s_cmp_ge_u32 s27, 2
    s_cbranch_scc1 L_t0done
    s_cmp_eq_u32 s75, 1
    s_cbranch_scc1 L_t0w
    buffer_load_dword v60, v6, s[4:7], s94 offen
    s_branch L_t0done
L_t0w:
    buffer_load_dword v60, v7, s[8:11], s94 offen
L_t0done:
    s_bitcmp1_b32 s68, 4
    s_cselect_b64 vcc, -1, 0
    s_bfe_u32 s28, s27, 0x10001
    s_and_b32 s29, s27, 1
    s_lshl_b32 s29, s29, 1
    s_lshr_b32 s36, s27, 2
    s_add_u32 s29, s29, s36
    v_cndmask_b32 v29, v6, v7, vcc
    s_add_u32 s20, s58, 18907136
    s_addc_u32 s21, s59, 0
    s_mov_b32 s22, 262144
    s_mov_b32 s23, 0x20000
    s_lshl_b32 s44, s24, 4
    s_add_u32 s44, s44, s25
    s_cmp_eq_u32 s27, 7
    s_cbranch_scc0 L_noclear
    s_lshl_b32 s36, s44, 3
    s_add_u32 s36, s36, s26
    s_lshl_b32 s36, s36, 10
    v_lshlrev_b32 v6, 7, v1
    v_mov_b32 v63, 0
    s_mov_b64 exec, 0xff
    buffer_atomic_swap v63, v6, s[20:23], s36 offen sc0 sc1
    s_mov_b64 exec, -1
L_noclear:
    s_lshr_b32 s30, s68, 1
    s_add_u32 s31, s27, 4
    s_lshr_b32 s75, s30, 3
    s_and_b32 s30, s30, 7
    s_and_b32 s36, s25, 8
    s_add_u32 s36, s36, s30
    s_mul_i32 s36, s36, 81920
    s_lshl_b32 s37, s31, 7
    s_add_u32 s94, s36, s37
    s_and_b32 s36, s26, 4
    s_lshl_b32 s36, s36, 1
    s_add_u32 s36, s36, s30
    s_lshl_b32 s37, s31, 4
    s_add_u32 s36, s36, s37
    s_mul_i32 s36, s36, 15360
    s_cmp_eq_u32 s75, 1
    s_cselect_b32 s94, s36, s94
    s_cmp_lt_u32 s27, 6
    s_cselect_b32 s93, 2, 0
    s_and_b32 s36, s46, 127
    s_cmp_gt_u32 s36, 48
    s_cselect_b32 s93, 0, s93
    s_cselect_b32 s71, 1, 0
    v_lshrrev_b32 v6, 3, v1
    s_lshl_b32 s36, s27, 3
    s_lshl_b32 s37, s26, 8
    s_add_u32 s36, s36, s37
    v_add_u32 v6, s36, v6
    v_mul_u32_u24 v6, 1280, v6
    s_and_b32 s36, s27, 1
    s_lshl_b32 s36, s36, 2
    v_and_b32 v3, 7, v1
    v_xor_b32 v3, v3, v4
    v_xor_b32 v3, s36, v3
    v_lshl_add_u32 v6, v3, 4, v6
    s_lshl_b32 s45, s27, 10
    s_and_b32 s30, s25, 3
    s_xor_b32 s36, s30, 0
    s_mul_i32 s37, s36, 81920
    s_lshl_b32 s36, s36, 13
    s_add_u32 s96, s36, s45
    v_add_u32 v8, s37, v6
    s_xor_b32 s36, s30, 1
    s_mul_i32 s37, s36, 81920
    s_lshl_b32 s36, s36, 13
    s_add_u32 s97, s36, s45
    v_add_u32 v9, s37, v6
    s_xor_b32 s36, s30, 2
    s_mul_i32 s37, s36, 81920
    s_lshl_b32 s36, s36, 13
    s_add_u32 s98, s36, s45
    v_add_u32 v10, s37, v6
    s_xor_b32 s36, s30, 3
    s_mul_i32 s37, s36, 81920
    s_lshl_b32 s36, s36, 13
    s_add_u32 s99, s36, s45
    v_add_u32 v11, s37, v6
    s_and_b32 s36, s27, 2
    v_lshl_add_u32 v3, v4, 2, s36
    v_xor_b32 v2, v2, v3
    v_lshl_add_u32 v5, v2, 4, v5
    v_cmp_le_u32 vcc, 5, v2
    s_mul_i32 s36, s27, 15360
    s_add_u32 s36, s36, s46
    v_add_u32 v3, 1200, v5
    v_cndmask_b32 v5, v5, v3, vcc
    v_cmp_le_u32 vcc, 11, v2
    v_add_u32 v3, 1184, v5
    v_mov_b32 v6, 0x80000000
    v_cndmask_b32 v5, v5, v3, vcc
    v_cmp_eq_u32 vcc, 10, v2
    v_add_u32 v5, s36, v5
    s_add_u32 s45, s45, 32768
    v_cndmask_b32 v5, v5, v6, vcc
    s_and_b32 s30, s26, 1
    s_xor_b32 s36, s30, 0
    s_mul_i32 s37, s36, 122880
    s_lshl_b32 s36, s36, 13
    s_add_u32 s100, s36, s45
    v_add_u32 v12, s37, v5
    s_xor_b32 s36, s30, 1
    s_mul_i32 s37, s36, 122880
    s_lshl_b32 s36, s36, 13
    s_add_u32 s101, s36, s45
    v_add_u32 v13, s37, v5
    s_mov_b32 s33, 0
    s_mov_b32 s34, 0
    v_and_b32 v2, 15, v1
    v_lshrrev_b32 v3, 4, v1
    v_lshrrev_b32 v4, 1, v2
    v_xor_b32 v4, v4, v3
    v_lshlrev_b32 v5, 7, v2
    v_lshl_add_u32 v5, v4, 4, v5
    s_lshl_b32 s36, s29, 13
    v_add_u32 v84, s36, v5
    v_xor_b32 v85, 64, v84
    v_bfe_u32 v4, v1, 2, 2
    v_lshl_add_u32 v5, v3, 3, v4
    v_lshlrev_b32 v5, 8, v5
    v_add_u32 v5, 32768, v5
    v_lshlrev_b32 v4, 3, v4
    v_and_b32 v6, 1, v3
    v_lshl_add_u32 v4, v6, 2, v4
    v_and_b32 v6, 3, v1
    v_lshlrev_b32 v6, 3, v6
    s_cmp_eq_u32 s28, 0
    s_mov_b32 s36, 0x3010200
    s_cselect_b32 s36, s36, 0x9070806
    v_lshrrev_b32 v7, v6, s36
    v_and_b32 v7, 31, v7
    v_xor_b32 v7, v7, v4
    v_lshl_add_u32 v86, v7, 3, v5
    s_mov_b32 s36, 0x150e1a04
    s_cselect_b32 s36, s36, 0x140f1b05
    v_lshrrev_b32 v7, v6, s36
    v_and_b32 v7, 31, v7
    v_xor_b32 v7, v7, v4
    v_lshl_add_u32 v87, v7, 3, v5
    s_mov_b32 s36, 0xd0b0c0a
    s_cselect_b32 s36, s36, 0x13111210
    v_lshrrev_b32 v7, v6, s36
    v_and_b32 v7, 31, v7
    v_xor_b32 v7, v7, v4
    v_lshl_add_u32 v88, v7, 3, v5
    s_mov_b32 s36, 0x19181716
    s_cselect_b32 s36, s36, 0x1f1e1d1c
    v_lshrrev_b32 v7, v6, s36
    v_and_b32 v7, 31, v7
    v_xor_b32 v7, v7, v4
    v_lshl_add_u32 v89, v7, 3, v5
    v_mov_b64 v[14:15], v[84:85]
    v_mov_b64 v[16:17], v[86:87]
    v_mov_b64 v[18:19], v[88:89]
    s_cmp_ge_u32 s27, 4
    s_cbranch_scc1 L_d0late
    s_add_u32 m0, s100, 0
    s_nop 0
    buffer_load_dwordx4 v12, s[8:11], s34 offen lds
    s_add_u32 m0, s96, 0
    s_nop 0
    buffer_load_dwordx4 v8, s[4:7], s33 offen lds
    s_add_u32 m0, s97, 0
    s_nop 0
    buffer_load_dwordx4 v9, s[4:7], s33 offen lds
    s_add_u32 m0, s98, 0
    s_nop 0
    buffer_load_dwordx4 v10, s[4:7], s33 offen lds
    s_add_u32 m0, s99, 0
    s_nop 0
    buffer_load_dwordx4 v11, s[4:7], s33 offen lds
    s_add_u32 m0, s101, 0
    s_nop 0
    buffer_load_dwordx4 v13, s[8:11], s34 offen lds
L_d0late:
    s_mul_i32 s36, s44, 393216
    s_add_u32 s12, s58, s36
    s_addc_u32 s13, s59, 0
    s_mov_b32 s14, 393216
    s_mov_b32 s15, 0x20000
    s_mul_i32 s36, s24, 2637824
    s_add_u32 s36, s36, 12582912
    s_add_u32 s16, s58, s36
    s_addc_u32 s17, s59, 0
    s_mov_b32 s18, 2637824
    s_mov_b32 s19, 0x20000
    s_cmp_eq_u32 s24, 0
    s_cselect_b32 s84, s52, s78
    s_cselect_b32 s85, s53, s79
    s_mov_b32 s86, 819200
    s_mov_b32 s87, 0x20000
    s_lshl_b32 s36, s24, 7
    s_add_u32 s88, s82, s36
    s_addc_u32 s89, s83, 0
    s_mov_b32 s90, 128
    s_mov_b32 s91, 0x20000
    s_mov_b32 s42, 0
    s_mov_b32 s43, -1
    s_mov_b32 s38, 0x3ea52b5c
    s_mov_b32 s39, 0x3ea52b5c
    s_mov_b32 s47, 0x80000
    s_lshl_b32 s69, s44, 6
    s_add_u32 s69, s69, s27
    s_lshl_b32 s69, s69, 7
    s_cmp_eq_u32 s27, 7
    s_cselect_b32 s73, 1540, 0
    v_cmp_gt_u32 vcc, 16, v1
    v_mov_b32 v7, s38
    v_and_b32 v6, 16, v1
    v_cndmask_b32 v92, 1.0, v7, vcc
    v_cmp_eq_u32 vcc, 0, v6
    v_and_b32 v2, 31, v1
    v_lshrrev_b32 v3, 5, v1
    v_lshlrev_b32 v4, 4, v1
    s_mul_i32 s36, s28, 20480
    s_mul_i32 s37, s29, 5120
    s_add_u32 s37, s37, s36
    v_add_u32 v20, s36, v4
    v_add_u32 v23, s37, v4
    s_add_u32 s36, s36, 2048
    s_add_u32 s37, s37, 2048
    v_lshl_add_u32 v21, v1, 3, s36
    v_lshl_add_u32 v83, v1, 3, s37
    s_add_u32 s36, s36, 512
    v_add_u32 v44, 49152, v83
    v_and_b32 v5, 3, v1
    v_bfe_u32 v6, v1, 4, 1
    v_lshl_add_u32 v5, v6, 2, v5
    v_bfe_u32 v7, v1, 2, 2
    v_lshl_add_u32 v5, v5, 3, v7
    v_lshl_add_u32 v5, v5, 3, s37
    v_add_u32 v45, 49152, v5
    s_add_u32 s37, s37, 512
    v_mul_u32_u24 v5, 640, v6
    v_lshl_add_u32 v5, v3, 8, v5
    v_and_b32 v7, 15, v1
    v_lshlrev_b32 v6, 2, v3
    v_xor_b32 v7, v7, v6
    v_lshl_add_u32 v5, v7, 4, v5
    v_add_u32 v95, s37, v5
    v_add_u32 v90, 98304, v95
    v_lshrrev_b32 v5, 3, v2
    v_mul_u32_u24 v5, 640, v5
    v_and_b32 v6, 7, v1
    v_lshl_add_u32 v5, v6, 4, v5
    s_add_u32 s37, s37, 512
    v_add_u32 v30, s37, v5
    v_add_u32 v91, 98304, v30
    v_lshlrev_b32 v5, 8, v3
    v_mov_b32 v6, 512
    v_cndmask_b32 v5, v6, v5, vcc
    v_lshl_add_u32 v5, v7, 4, v5
    v_add_u32 v22, s36, v5
    v_cmp_eq_u32 vcc, 20, v2
    v_mov_b32 v5, 0x3f803f80
    s_mov_b32 s50, 0xfffff
    v_cndmask_b32 v48, 0, v5, vcc
    v_cndmask_b32 v49, 0, v5, vcc
    s_mov_b32 s51, 0xfffff
    v_mov_b64 v[50:51], v[48:49]
    v_mov_b64 v[52:53], v[48:49]
    v_mov_b64 v[54:55], v[48:49]
    v_and_b32 v24, 7, v1
    v_lshlrev_b32 v24, 10, v24
    v_bfe_u32 v5, v1, 3, 1
    v_lshl_add_u32 v24, v5, 9, v24
    v_mov_b32 v28, 0
    s_lshl_b32 s36, s26, 4
    s_lshl_b32 s37, s29, 2
    s_add_u32 s36, s36, s37
    s_mul_i32 s36, s36, 20608
    v_lshrrev_b32 v4, 4, v2
    v_mul_u32_u24 v4, 20608, v4
    v_and_b32 v2, 15, v2
    v_lshl_add_u32 v4, v2, 4, v4
    v_lshl_add_u32 v4, v3, 8, v4
    s_lshl_b32 s37, s25, 1
    s_add_u32 s37, s37, s28
    s_lshl_b32 s37, s37, 9
    s_add_u32 s37, s37, s36
    v_add_u32 v25, s37, v4
    v_lshrrev_b32 v4, 4, v1
    v_mul_u32_u24 v4, 20608, v4
    v_lshl_add_u32 v4, v2, 3, v4
    s_lshr_b32 s37, s25, 2
    s_lshl_b32 s37, s37, 10
    s_add_u32 s36, s36, s37
    s_and_b32 s37, s25, 1
    s_lshl_b32 s37, s37, 9
    s_add_u32 s36, s36, s37
    s_and_b32 s37, s25, 2
    s_add_u32 s37, s37, s28
    s_lshl_b32 s37, s37, 7
    s_add_u32 s36, s36, s37
    s_add_u32 s36, s36, 16384
    v_add_u32 v26, s36, v4
    s_cmp_lt_u32 s27, 4
    s_cbranch_scc1 L_d0done
    s_add_u32 m0, s100, 0
    s_nop 0
    buffer_load_dwordx4 v12, s[8:11], s34 offen lds
    s_add_u32 m0, s96, 0
    s_nop 0
    buffer_load_dwordx4 v8, s[4:7], s33 offen lds
    s_add_u32 m0, s97, 0
    s_nop 0
    buffer_load_dwordx4 v9, s[4:7], s33 offen lds
    s_add_u32 m0, s98, 0
    s_nop 0
    buffer_load_dwordx4 v10, s[4:7], s33 offen lds
    s_add_u32 m0, s99, 0
    s_nop 0
    buffer_load_dwordx4 v11, s[4:7], s33 offen lds
    s_add_u32 m0, s101, 0
    s_nop 0
    buffer_load_dwordx4 v13, s[8:11], s34 offen lds
L_d0done:
    s_barrier
    s_add_u32 s33, s33, 128
    s_add_u32 s34, s34, 245760
    s_add_u32 m0, s100, 49152
    s_nop 0
    buffer_load_dwordx4 v12, s[8:11], s34 offen lds
    s_add_u32 m0, s96, 49152
    s_nop 0
    buffer_load_dwordx4 v8, s[4:7], s33 offen lds
    s_add_u32 m0, s97, 49152
    s_nop 0
    buffer_load_dwordx4 v9, s[4:7], s33 offen lds
    s_add_u32 m0, s98, 49152
    s_nop 0
    buffer_load_dwordx4 v10, s[4:7], s33 offen lds
    s_add_u32 m0, s99, 49152
    s_nop 0
    buffer_load_dwordx4 v11, s[4:7], s33 offen lds
    s_add_u32 m0, s101, 49152
    s_nop 0
    buffer_load_dwordx4 v13, s[8:11], s34 offen lds
    s_add_u32 s33, s33, 128
    s_add_u32 s34, s34, 245760
    s_mov_b32 s30, 0
    s_mov_b32 s31, 0
    s_mov_b32 s35, 98304
    s_waitcnt vmcnt(6)
    s_barrier
    s_cmp_eq_u32 s93, 2
    s_cbranch_scc0 L_tda
    s_cmp_eq_u32 s75, 1
    s_cbranch_scc1 L_twa
    buffer_load_dword v61, v29, s[4:7], s94 offen
    s_branch L_tda
L_twa:
    buffer_load_dword v61, v29, s[8:11], s94 offen
L_tda:
    ds_read_b128 v[224:227], v14 offset:0
    ds_read_b64_tr_b16 v[248:249], v18 offset:0
    ds_read_b64_tr_b16 v[250:251], v18 offset:1024
    ds_read_b128 v[228:231], v14 offset:2048
    ds_read_b64_tr_b16 v[244:245], v17 offset:0
    ds_read_b64_tr_b16 v[246:247], v17 offset:1024
    ds_read_b128 v[232:235], v14 offset:4096
    ds_read_b64_tr_b16 v[240:241], v16 offset:0
    ds_read_b64_tr_b16 v[242:243], v16 offset:1024
    ds_read_b128 v[236:239], v14 offset:6144
    ds_read_b64_tr_b16 v[252:253], v19 offset:0
    ds_read_b64_tr_b16 v[254:255], v19 offset:1024
    s_waitcnt lgkmcnt(0)
    v_mfma_f32_16x16x32_bf16 v[160:163], v[248:251], v[224:227], 0
    ds_read_b128 v[96:99], v15 offset:0
    s_mov_b32 s32, s31
    s_add_u32 s31, s31, 49152
    s_cmp_eq_u32 s31, 147456
    s_cselect_b32 s31, 0, s31
    s_add_u32 s30, s30, 1
    v_add_u32 v14, s31, v84
    s_mul_i32 s41, s26, 49152
    s_and_b32 s36, s25, 7
    v_mfma_f32_16x16x32_bf16 v[164:167], v[248:251], v[228:231], 0
    ds_read_b64_tr_b16 v[120:121], v18 offset:8192
    s_mul_i32 s36, s36, 160
    s_movk_i32 s37, 1120
    v_mfma_f32_16x16x32_bf16 v[168:171], v[248:251], v[232:235], 0
    ds_read_b64_tr_b16 v[122:123], v18 offset:9216
    v_add_u32 v5, 0, v1
    v_lshl_add_u32 v3, v5, 4, s36
    v_mfma_f32_16x16x32_bf16 v[172:175], v[248:251], v[236:239], 0
    s_cmp_eq_u32 s71, 1
    s_cbranch_scc0 L_g3
    s_add_u32 m0, s100, s35
    s_nop 0
    buffer_load_dwordx4 v12, s[8:11], s34 offen lds
L_g3:
    v_mul_u32_u24 v5, 6554, v5
    v_lshrrev_b32 v5, 16, v5
    v_mfma_f32_16x16x32_bf16 v[144:147], v[244:247], v[224:227], 0
    ds_read_b128 v[100:103], v15 offset:2048
    v_mad_u32_u24 v64, v5, s37, v3
    v_add_u32 v5, 64, v1
    v_mfma_f32_16x16x32_bf16 v[148:151], v[244:247], v[228:231], 0
    ds_read_b64_tr_b16 v[116:117], v17 offset:8192
    v_lshl_add_u32 v3, v5, 4, s36
    v_mul_u32_u24 v5, 6554, v5
    v_mfma_f32_16x16x32_bf16 v[152:155], v[244:247], v[232:235], 0
    ds_read_b64_tr_b16 v[118:119], v17 offset:9216
    v_lshrrev_b32 v5, 16, v5
    v_mad_u32_u24 v65, v5, s37, v3
    v_mfma_f32_16x16x32_bf16 v[156:159], v[244:247], v[236:239], 0
    ds_read_b128 v[104:107], v15 offset:4096
    v_add_u32 v5, 128, v1
    v_lshl_add_u32 v3, v5, 4, s36
    v_mfma_f32_16x16x32_bf16 v[128:131], v[240:243], v[224:227], 0
    s_cmp_eq_u32 s71, 1
    s_cbranch_scc0 L_g8
    s_add_u32 m0, s96, s35
    s_nop 0
    buffer_load_dwordx4 v8, s[4:7], s33 offen lds
L_g8:
    v_mul_u32_u24 v5, 6554, v5
    v_lshrrev_b32 v5, 16, v5
    v_mfma_f32_16x16x32_bf16 v[132:135], v[240:243], v[228:231], 0
    ds_read_b64_tr_b16 v[112:113], v16 offset:8192
    v_mad_u32_u24 v66, v5, s37, v3
    v_add_u32 v5, 192, v1
    v_mfma_f32_16x16x32_bf16 v[136:139], v[240:243], v[232:235], 0
    ds_read_b64_tr_b16 v[114:115], v16 offset:9216
    v_lshl_add_u32 v3, v5, 4, s36
    v_mul_u32_u24 v5, 6554, v5
    v_mfma_f32_16x16x32_bf16 v[140:143], v[240:243], v[236:239], 0
    ds_read_b128 v[108:111], v15 offset:6144
    v_lshrrev_b32 v5, 16, v5
    v_mad_u32_u24 v67, v5, s37, v3
    v_mfma_f32_16x16x32_bf16 v[176:179], v[224:227], v[252:255], 0
    s_cmp_eq_u32 s71, 1
    s_cbranch_scc0 L_g12
    s_add_u32 m0, s97, s35
    s_nop 0
    buffer_load_dwordx4 v9, s[4:7], s33 offen lds
L_g12:
    v_add_u32 v5, 256, v1
    v_lshl_add_u32 v3, v5, 4, s36
    v_mfma_f32_16x16x32_bf16 v[180:183], v[228:231], v[252:255], 0
    ds_read_b64_tr_b16 v[124:125], v19 offset:8192
    v_mul_u32_u24 v5, 6554, v5
    v_lshrrev_b32 v5, 16, v5
    v_mfma_f32_16x16x32_bf16 v[184:187], v[232:235], v[252:255], 0
    ds_read_b64_tr_b16 v[126:127], v19 offset:9216
    v_mad_u32_u24 v68, v5, s37, v3
    s_and_b32 s72, s27, 3
    v_mfma_f32_16x16x32_bf16 v[188:191], v[236:239], v[252:255], 0
    v_add_u32 v15, s31, v85
    v_add_u32 v16, s31, v86
    v_add_u32 v17, s31, v87
    v_add_u32 v18, s31, v88
    v_add_u32 v19, s31, v89
    s_cmp_eq_u32 s71, 1
    s_cbranch_scc1 L_p6
    s_add_u32 m0, s100, s35
    s_nop 0
    buffer_load_dwordx4 v12, s[8:11], s34 offen lds
    s_add_u32 m0, s96, s35
    s_nop 0
    buffer_load_dwordx4 v8, s[4:7], s33 offen lds
    s_add_u32 m0, s97, s35
    s_nop 0
    buffer_load_dwordx4 v9, s[4:7], s33 offen lds
    s_cmp_eq_u32 s93, 2
    s_cbranch_scc1 L_p7
L_p6:
    s_waitcnt vmcnt(3)
L_p7:
    s_waitcnt vmcnt(4) lgkmcnt(0)
    s_barrier
    v_mfma_f32_16x16x32_bf16 v[160:163], v[120:123], v[96:99], v[160:163]
    ds_read_b128 v[224:227], v14 offset:0
    s_mul_i32 s36, s72, 10240
    v_lshl_add_u32 v77, v1, 4, s36
    v_mfma_f32_16x16x32_bf16 v[164:167], v[120:123], v[100:103], v[164:167]
    ds_read_b64_tr_b16 v[248:249], v18 offset:0
    s_mul_i32 s36, s72, 3072
    s_add_u32 s36, s36, 151552
    v_mfma_f32_16x16x32_bf16 v[168:171], v[120:123], v[104:107], v[168:171]
    ds_read_b64_tr_b16 v[250:251], v18 offset:1024
    v_lshl_add_u32 v78, v1, 4, s36
    v_mov_b64 v[192:193], 0
    s_add_u32 m0, s98, s35
    v_mfma_f32_16x16x32_bf16 v[172:175], v[120:123], v[108:111], v[172:175]
    buffer_load_dwordx4 v10, s[4:7], s33 offen lds
    v_mov_b64 v[194:195], 0
    v_mov_b64 v[196:197], 0
    v_mfma_f32_16x16x32_bf16 v[144:147], v[116:119], v[96:99], v[144:147]
    ds_read_b128 v[228:231], v14 offset:2048
    v_mov_b64 v[198:199], 0
    v_mov_b64 v[200:201], 0
    v_mfma_f32_16x16x32_bf16 v[148:151], v[116:119], v[100:103], v[148:151]
    ds_read_b64_tr_b16 v[244:245], v17 offset:0
    v_mov_b64 v[202:203], 0
    v_mov_b64 v[204:205], 0
    v_mfma_f32_16x16x32_bf16 v[152:155], v[116:119], v[104:107], v[152:155]
    ds_read_b64_tr_b16 v[246:247], v17 offset:1024
    v_mov_b64 v[206:207], 0
    v_mov_b64 v[208:209], 0
    v_mfma_f32_16x16x32_bf16 v[156:159], v[116:119], v[108:111], v[156:159]
    ds_read_b128 v[232:235], v14 offset:4096
    v_mov_b64 v[210:211], 0
    v_mov_b64 v[212:213], 0
    s_add_u32 m0, s99, s35
    v_mfma_f32_16x16x32_bf16 v[128:131], v[112:115], v[96:99], v[128:131]
    buffer_load_dwordx4 v11, s[4:7], s33 offen lds
    v_mov_b64 v[214:215], 0
    v_mov_b64 v[216:217], 0
    v_mfma_f32_16x16x32_bf16 v[132:135], v[112:115], v[100:103], v[132:135]
    ds_read_b64_tr_b16 v[240:241], v16 offset:0
    v_mov_b64 v[218:219], 0
    v_mov_b64 v[220:221], 0
    v_mfma_f32_16x16x32_bf16 v[136:139], v[112:115], v[104:107], v[136:139]
    ds_read_b64_tr_b16 v[242:243], v16 offset:1024
    v_mov_b64 v[222:223], 0
    v_add_u32 v57, 98304, v20
    v_mfma_f32_16x16x32_bf16 v[140:143], v[112:115], v[108:111], v[140:143]
    ds_read_b128 v[236:239], v14 offset:6144
    v_add_u32 v58, 98304, v21
    v_add_u32 v59, 98304, v22
    s_add_u32 m0, s101, s35
    v_mfma_f32_16x16x32_bf16 v[176:179], v[96:99], v[124:127], v[176:179]
    buffer_load_dwordx4 v13, s[8:11], s34 offen lds
    v_add_u32 v93, 98304, v23
    v_add_u32 v94, 98304, v83
    v_mfma_f32_16x16x32_bf16 v[180:183], v[100:103], v[124:127], v[180:183]
    ds_read_b64_tr_b16 v[252:253], v19 offset:0
    v_mov_b32 v56, 0xdddddddd
    s_mov_b32 s95, 0
    v_mfma_f32_16x16x32_bf16 v[184:187], v[104:107], v[124:127], v[184:187]
    ds_read_b64_tr_b16 v[254:255], v19 offset:1024
    s_add_u32 s33, s33, 128
    s_add_u32 s34, s34, 245760
    s_cmp_ge_u32 s30, 8
    s_cselect_b32 s35, 196608, s32
    s_cselect_b32 s6, 0, s6
    s_cselect_b32 s10, 0, s10
    s_mov_b32 s92, 0xff
    s_bitset0_b32 s92, s26
    v_mfma_f32_16x16x32_bf16 v[188:191], v[108:111], v[124:127], v[188:191]
.p2align 3
L_gemm:
    s_waitcnt lgkmcnt(0)
    v_mfma_f32_16x16x32_bf16 v[160:163], v[248:251], v[224:227], v[160:163]
    ds_read_b128 v[96:99], v15 offset:0
    ds_read_b64_tr_b16 v[120:121], v18 offset:8192
    s_setprio 1
    s_mov_b32 s32, s31
    s_add_u32 s31, s31, 49152
    s_cmp_eq_u32 s31, 147456
    s_cselect_b32 s31, 0, s31
    s_add_u32 s30, s30, 1
    v_add_u32 v14, s31, v84
    v_mfma_f32_16x16x32_bf16 v[164:167], v[248:251], v[228:231], v[164:167]
    ds_read_b64_tr_b16 v[122:123], v18 offset:9216
    ds_read_b128 v[100:103], v15 offset:2048
    v_mfma_f32_16x16x32_bf16 v[168:171], v[248:251], v[232:235], v[168:171]
    ds_read_b64_tr_b16 v[116:117], v17 offset:8192
    ds_read_b64_tr_b16 v[118:119], v17 offset:9216
    s_add_u32 m0, s100, s35
    v_mfma_f32_16x16x32_bf16 v[172:175], v[248:251], v[236:239], v[172:175]
    buffer_load_dwordx4 v12, s[8:11], s34 offen lds
    v_mfma_f32_16x16x32_bf16 v[144:147], v[244:247], v[224:227], v[144:147]
    ds_read_b128 v[104:107], v15 offset:4096
    ds_read_b64_tr_b16 v[112:113], v16 offset:8192
    v_mfma_f32_16x16x32_bf16 v[148:151], v[244:247], v[228:231], v[148:151]
    ds_read_b64_tr_b16 v[114:115], v16 offset:9216
    ds_read_b128 v[108:111], v15 offset:6144
    v_mfma_f32_16x16x32_bf16 v[152:155], v[244:247], v[232:235], v[152:155]
    ds_read_b64_tr_b16 v[124:125], v19 offset:8192
    ds_read_b64_tr_b16 v[126:127], v19 offset:9216
    v_mfma_f32_16x16x32_bf16 v[156:159], v[244:247], v[236:239], v[156:159]
    s_setprio 0
    s_add_u32 m0, s96, s35
    v_mfma_f32_16x16x32_bf16 v[128:131], v[240:243], v[224:227], v[128:131]
    buffer_load_dwordx4 v8, s[4:7], s33 offen lds
    v_mfma_f32_16x16x32_bf16 v[132:135], v[240:243], v[228:231], v[132:135]
    v_add_u32 v15, s31, v85
    v_mfma_f32_16x16x32_bf16 v[136:139], v[240:243], v[232:235], v[136:139]
    v_add_u32 v16, s31, v86
    v_mfma_f32_16x16x32_bf16 v[140:143], v[240:243], v[236:239], v[140:143]
    v_add_u32 v17, s31, v87
    s_add_u32 m0, s97, s35
    v_mfma_f32_16x16x32_bf16 v[176:179], v[224:227], v[252:255], v[176:179]
    buffer_load_dwordx4 v9, s[4:7], s33 offen lds
    v_mfma_f32_16x16x32_bf16 v[180:183], v[228:231], v[252:255], v[180:183]
    v_add_u32 v18, s31, v88
    v_mfma_f32_16x16x32_bf16 v[184:187], v[232:235], v[252:255], v[184:187]
    v_add_u32 v19, s31, v89
    v_mfma_f32_16x16x32_bf16 v[188:191], v[236:239], v[252:255], v[188:191]
    s_bitcmp1_b32 s73, s30
    s_cbranch_scc1 L_w7
L_w7_ret:
    s_cmp_eq_u32 s30, 10
    s_cbranch_scc1 L_last
    s_waitcnt vmcnt(3) lgkmcnt(0)
    s_barrier
    v_mfma_f32_16x16x32_bf16 v[160:163], v[120:123], v[96:99], v[160:163]
    ds_read_b128 v[224:227], v14 offset:0
    ds_read_b64_tr_b16 v[248:249], v18 offset:0
    s_setprio 2
    v_mfma_f32_16x16x32_bf16 v[164:167], v[120:123], v[100:103], v[164:167]
    ds_read_b64_tr_b16 v[250:251], v18 offset:1024
    ds_read_b128 v[228:231], v14 offset:2048
    v_mfma_f32_16x16x32_bf16 v[168:171], v[120:123], v[104:107], v[168:171]
    ds_read_b64_tr_b16 v[244:245], v17 offset:0
    ds_read_b64_tr_b16 v[246:247], v17 offset:1024
    s_add_u32 m0, s98, s35
    v_mfma_f32_16x16x32_bf16 v[172:175], v[120:123], v[108:111], v[172:175]
    buffer_load_dwordx4 v10, s[4:7], s33 offen lds
    v_mfma_f32_16x16x32_bf16 v[144:147], v[116:119], v[96:99], v[144:147]
    ds_read_b128 v[232:235], v14 offset:4096
    ds_read_b64_tr_b16 v[240:241], v16 offset:0
    v_mfma_f32_16x16x32_bf16 v[148:151], v[116:119], v[100:103], v[148:151]
    ds_read_b64_tr_b16 v[242:243], v16 offset:1024
    ds_read_b128 v[236:239], v14 offset:6144
    v_mfma_f32_16x16x32_bf16 v[152:155], v[116:119], v[104:107], v[152:155]
    ds_read_b64_tr_b16 v[252:253], v19 offset:0
    ds_read_b64_tr_b16 v[254:255], v19 offset:1024
    v_mfma_f32_16x16x32_bf16 v[156:159], v[116:119], v[108:111], v[156:159]
    s_setprio 2
    s_add_u32 m0, s99, s35
    v_mfma_f32_16x16x32_bf16 v[128:131], v[112:115], v[96:99], v[128:131]
    buffer_load_dwordx4 v11, s[4:7], s33 offen lds
    v_mfma_f32_16x16x32_bf16 v[132:135], v[112:115], v[100:103], v[132:135]
    v_mfma_f32_16x16x32_bf16 v[136:139], v[112:115], v[104:107], v[136:139]
    v_mfma_f32_16x16x32_bf16 v[140:143], v[112:115], v[108:111], v[140:143]
    s_add_u32 m0, s101, s35
    v_mfma_f32_16x16x32_bf16 v[176:179], v[96:99], v[124:127], v[176:179]
    buffer_load_dwordx4 v13, s[8:11], s34 offen lds
    v_mfma_f32_16x16x32_bf16 v[180:183], v[100:103], v[124:127], v[180:183]
    v_mfma_f32_16x16x32_bf16 v[184:187], v[104:107], v[124:127], v[184:187]
    s_add_u32 s33, s33, 128
    s_add_u32 s34, s34, 245760
    s_cmp_ge_u32 s30, 8
    s_cselect_b32 s35, 196608, s32
    s_cselect_b32 s6, 0, s6
    s_cselect_b32 s10, 0, s10
    v_mfma_f32_16x16x32_bf16 v[188:191], v[108:111], v[124:127], v[188:191]
    s_branch L_gemm
L_last:
    s_setprio 0
    s_waitcnt lgkmcnt(0)
    v_mfma_f32_16x16x32_bf16 v[160:163], v[120:123], v[96:99], v[160:163]
    v_mfma_f32_16x16x32_bf16 v[164:167], v[120:123], v[100:103], v[164:167]
    v_mfma_f32_16x16x32_bf16 v[168:171], v[120:123], v[104:107], v[168:171]
    v_mfma_f32_16x16x32_bf16 v[172:175], v[120:123], v[108:111], v[172:175]
    v_mfma_f32_16x16x32_bf16 v[144:147], v[116:119], v[96:99], v[144:147]
    v_mfma_f32_16x16x32_bf16 v[148:151], v[116:119], v[100:103], v[148:151]
    v_mfma_f32_16x16x32_bf16 v[152:155], v[116:119], v[104:107], v[152:155]
    v_mfma_f32_16x16x32_bf16 v[156:159], v[116:119], v[108:111], v[156:159]
    v_mfma_f32_16x16x32_bf16 v[128:131], v[112:115], v[96:99], v[128:131]
    v_cvt_pk_bf16_f32 v224, v160, v161
    v_cvt_pk_bf16_f32 v225, v162, v163
    v_cvt_pk_bf16_f32 v226, v164, v165
    v_mfma_f32_16x16x32_bf16 v[132:135], v[112:115], v[100:103], v[132:135]
    v_cvt_pk_bf16_f32 v227, v166, v167
    v_cvt_pk_bf16_f32 v228, v168, v169
    v_cvt_pk_bf16_f32 v229, v170, v171
    v_mfma_f32_16x16x32_bf16 v[136:139], v[112:115], v[104:107], v[136:139]
    v_cvt_pk_bf16_f32 v230, v172, v173
    v_cvt_pk_bf16_f32 v231, v174, v175
    v_permlane16_swap_b32 v224, v226
    v_mfma_f32_16x16x32_bf16 v[140:143], v[112:115], v[108:111], v[140:143]
    v_permlane16_swap_b32 v225, v227
    ds_write_b128 v93, v[224:227]
    buffer_store_dwordx4 v[224:227], v23, s[12:15], s41 offen sc1
    v_mfma_f32_16x16x32_bf16 v[176:179], v[96:99], v[124:127], v[176:179]
    v_pk_mul_f32 v[144:145], v[144:145], v[92:93] op_sel_hi:[1,0]
    v_pk_mul_f32 v[146:147], v[146:147], v[92:93] op_sel_hi:[1,0]
    v_pk_mul_f32 v[148:149], v[148:149], v[92:93] op_sel_hi:[1,0]
    v_mfma_f32_16x16x32_bf16 v[180:183], v[100:103], v[124:127], v[180:183]
    v_pk_mul_f32 v[150:151], v[150:151], v[92:93] op_sel_hi:[1,0]
    v_pk_mul_f32 v[152:153], v[152:153], v[92:93] op_sel_hi:[1,0]
    v_pk_mul_f32 v[154:155], v[154:155], v[92:93] op_sel_hi:[1,0]
    v_mfma_f32_16x16x32_bf16 v[184:187], v[104:107], v[124:127], v[184:187]
    v_pk_mul_f32 v[156:157], v[156:157], v[92:93] op_sel_hi:[1,0]
    v_pk_mul_f32 v[158:159], v[158:159], v[92:93] op_sel_hi:[1,0]
    v_cvt_pk_bf16_f32 v40, v144, v145
    v_mfma_f32_16x16x32_bf16 v[188:191], v[108:111], v[124:127], v[188:191]
    v_cvt_pk_bf16_f32 v41, v146, v147
    v_cvt_pk_bf16_f32 v240, v148, v149
    v_cvt_pk_bf16_f32 v241, v150, v151
    v_cvt_pk_bf16_f32 v60, v152, v153
    v_cvt_pk_bf16_f32 v61, v154, v155
    v_cvt_pk_bf16_f32 v242, v156, v157
    v_cvt_pk_bf16_f32 v243, v158, v159
    v_permlane16_swap_b32 v40, v240
    v_permlane16_swap_b32 v41, v241
    v_permlane16_swap_b32 v60, v242
    v_permlane16_swap_b32 v61, v243
    v_permlane16_swap_b32 v228, v230
    v_permlane16_swap_b32 v229, v231
    v_permlane32_swap_b32 v40, v60
    v_permlane32_swap_b32 v41, v61
    v_permlane32_swap_b32 v240, v242
    v_permlane32_swap_b32 v241, v243
    v_mfma_f32_32x32x4_2b_bf16 v[96:127], v[60:61], v[40:41], 0
    ds_write_b64 v44, v[240:241]
    ds_write_b128 v93, v[228:231] offset:1024
    ds_write_b64 v94, v[60:61]
    v_pk_mul_f32 v[128:129], v[128:129], s[38:39]
    v_pk_mul_f32 v[130:131], v[130:131], s[38:39]
    v_pk_mul_f32 v[132:133], v[132:133], s[38:39]
    v_pk_mul_f32 v[134:135], v[134:135], s[38:39]
    v_pk_mul_f32 v[136:137], v[136:137], s[38:39]
    v_pk_mul_f32 v[138:139], v[138:139], s[38:39]
    v_pk_mul_f32 v[140:141], v[140:141], s[38:39]
    v_pk_mul_f32 v[142:143], v[142:143], s[38:39]
    v_cvt_pk_bf16_f32 v32, v128, v129
    v_cvt_pk_bf16_f32 v33, v130, v131
    v_cvt_pk_bf16_f32 v34, v132, v133
    v_cvt_pk_bf16_f32 v35, v134, v135
    s_waitcnt lgkmcnt(2)
    ds_read_b64_tr_b16 v[244:245], v45
    ds_read_b64_tr_b16 v[246:247], v45 offset:32
    v_cvt_pk_bf16_f32 v36, v136, v137
    v_cvt_pk_bf16_f32 v37, v138, v139
    v_cvt_pk_bf16_f32 v38, v140, v141
    v_cvt_pk_bf16_f32 v39, v142, v143
    v_permlane16_swap_b32 v32, v34
    v_permlane16_swap_b32 v33, v35
    v_permlane16_swap_b32 v36, v38
    v_permlane16_swap_b32 v37, v39
    v_mfma_f32_32x32x16_bf16 v[96:111], v[224:227], v[32:35], v[96:111]
    v_cvt_pk_bf16_f32 v232, v176, v177
    v_cvt_pk_bf16_f32 v233, v178, v179
    v_cvt_pk_bf16_f32 v234, v180, v181
    v_cvt_pk_bf16_f32 v235, v182, v183
    v_mfma_f32_32x32x16_bf16 v[112:127], v[228:231], v[36:39], v[112:127]
    v_cvt_pk_bf16_f32 v236, v184, v185
    v_cvt_pk_bf16_f32 v237, v186, v187
    v_cvt_pk_bf16_f32 v238, v188, v189
    v_cvt_pk_bf16_f32 v239, v190, v191
    v_permlane16_swap_b32 v232, v234
    v_permlane16_swap_b32 v233, v235
    ds_write_b128 v90, v[232:235]
    v_permlane16_swap_b32 v236, v238
    v_permlane16_swap_b32 v237, v239
    ds_write_b128 v90, v[236:239] offset:1280
    s_waitcnt lgkmcnt(2)
    s_mov_b64 exec, 0xffffffff
    ds_write_b128 v91, v[244:247]
    buffer_store_dwordx4 v[244:247], v30, s[12:15], s41 offen offset:0 sc1
    s_mov_b64 exec, -1
    buffer_store_dwordx4 v[228:231], v23, s[12:15], s41 offen offset:1024 sc1
    buffer_store_dwordx2 v[60:61], v83, s[12:15], s41 offen offset:0 sc1
    v_max3_f32 v2, v96, v97, v98
    v_max3_f32 v2, v2, v99, v100
    v_max3_f32 v2, v2, v101, v102
    v_max3_f32 v2, v2, v103, v104
    v_max3_f32 v2, v2, v105, v106
    v_max3_f32 v2, v2, v107, v108
    v_max3_f32 v2, v2, v109, v110
    v_max_f32 v2, v2, v111
    v_max3_f32 v3, v112, v113, v114
    v_max3_f32 v3, v3, v115, v116
    v_max3_f32 v3, v3, v117, v118
    v_max3_f32 v3, v3, v119, v120
    v_max3_f32 v3, v3, v121, v122
    v_max3_f32 v3, v3, v123, v124
    v_max3_f32 v3, v3, v125, v126
    v_max_f32 v3, v3, v127
    v_sub_f32 v2, 0x41e00000, v2
    v_sub_f32 v3, 0x41e00000, v3
    v_mov_b32 v4, v2
    v_mov_b32 v5, v3
    s_nop 0
    v_permlane32_swap_b32 v2, v4
    v_permlane32_swap_b32 v3, v5
    v_min_f32 v42, v2, v4
    v_min_f32 v43, v3, v5
    s_lshl_b32 s36, s26, 10
    s_mov_b32 s62, s41
    s_add_u32 s41, s69, s36
    s_cmp_ge_u32 s27, 4
    s_cbranch_scc1 L_helper
    buffer_store_dwordx4 v[232:235], v95, s[12:15], s62 offen offset:0 sc1
    buffer_store_dwordx4 v[236:239], v95, s[12:15], s62 offen offset:1280 sc1
    v_mov_b32 v3, 1
    s_waitcnt lgkmcnt(0)
    v_mov_b32 v224, v42
    v_mov_b32 v225, v42
    v_mov_b32 v240, v43
    v_mov_b32 v241, v43
    v_mov_b64 v[226:227], v[224:225]
    v_mov_b64 v[242:243], v[240:241]
    v_mov_b64 v[228:229], v[224:225]
    v_mov_b64 v[244:245], v[240:241]
    v_mov_b64 v[230:231], v[224:225]
    v_mov_b64 v[246:247], v[240:241]
    v_mov_b64 v[232:233], v[224:225]
    v_mov_b64 v[248:249], v[240:241]
    v_mov_b64 v[234:235], v[224:225]
    v_mov_b64 v[250:251], v[240:241]
    v_mov_b64 v[236:237], v[224:225]
    v_mov_b64 v[252:253], v[240:241]
    v_mov_b64 v[238:239], v[224:225]
    v_mov_b64 v[254:255], v[240:241]
    v_mov_b64 v[20:21], v[48:49]
    v_mov_b64 v[22:23], v[48:49]
    v_mov_b64 v[60:61], v[48:49]
    v_mov_b64 v[62:63], v[48:49]
    s_mov_b32 s30, 0
    s_mov_b32 s31, 98304
    s_mov_b32 s63, 49152
    s_barrier
    ds_read_b64 v[42:43], v58 offset:0
    ds_read_b128 v[16:19], v78 offset:2048
    ds_read_b128 v[44:47], v57 offset:0
    ds_read_b128 v[8:11], v78
    ds_read_b128 v[12:15], v78 offset:1024
    s_mov_b64 exec, s[50:51]
    ds_read_b128 v[48:51], v59 offset:0
    ds_read_b128 v[52:55], v59 offset:640
    s_mov_b64 exec, -1
    v_mov_b64 v[110:111], 0
    v_mov_b64 v[112:113], 0
    v_mov_b64 v[114:115], 0
    v_mov_b64 v[116:117], 0
    v_mov_b64 v[118:119], 0
    v_mov_b64 v[120:121], 0
    v_mov_b64 v[122:123], 0
    v_mov_b64 v[124:125], 0
    v_mov_b64 v[126:127], 0
    s_waitcnt lgkmcnt(6)
    v_mfma_f32_32x32x4_2b_bf16 v[128:159], v[42:43], v[40:41], v[224:255] cbsz:1 abid:0
    s_waitcnt lgkmcnt(4)
    v_mov_b32 v64, v18
    v_mov_b32 v65, v18
    v_mov_b32 v80, v19
    v_mov_b32 v81, v19
    v_mov_b64 v[66:67], v[64:65]
    v_mov_b64 v[82:83], v[80:81]
    v_mov_b64 v[68:69], v[64:65]
    v_mov_b64 v[84:85], v[80:81]
    v_mov_b64 v[70:71], v[64:65]
    v_mov_b64 v[86:87], v[80:81]
    v_mov_b64 v[72:73], v[64:65]
    v_mov_b64 v[88:89], v[80:81]
    v_mov_b64 v[74:75], v[64:65]
    v_mov_b64 v[90:91], v[80:81]
    v_mov_b64 v[76:77], v[64:65]
    v_mov_b64 v[92:93], v[80:81]
    v_mov_b64 v[78:79], v[64:65]
    v_mov_b64 v[94:95], v[80:81]
    v_mfma_f32_32x32x16_bf16 v[128:143], v[44:47], v[32:35], v[128:143]
    v_mfma_f32_32x32x16_bf16 v[144:159], v[44:47], v[36:39], v[144:159]
    v_mov_b64 v[184:185], 0
    v_mov_b64 v[186:187], 0
    v_mov_b64 v[188:189], 0
    v_mov_b64 v[190:191], 0
    v_mov_b64 v[96:97], 0
    v_mov_b64 v[98:99], 0
    v_mov_b64 v[100:101], 0
    v_mov_b64 v[102:103], 0
    v_mov_b64 v[104:105], 0
    v_mov_b64 v[106:107], 0
    v_mov_b64 v[108:109], 0
.p2align 6
L_attn:
    v_exp_f32 v128, v128
    v_exp_f32 v129, v129
    v_smfmac_f32_32x32x32_bf16 v[112:127], v[60:63], v[184:191], v56
    s_waitcnt lgkmcnt(0)
    v_exp_f32 v130, v130
    v_exp_f32 v131, v131
    v_exp_f32 v132, v132
    v_exp_f32 v133, v133
    v_mfma_f32_32x32x4_2b_bf16 v[160:191], v[42:43], v[16:17], v[64:95] cbsz:1 abid:0
    v_exp_f32 v134, v134
    v_exp_f32 v135, v135
    v_exp_f32 v136, v136
    v_exp_f32 v137, v137
    v_exp_f32 v138, v138
    v_exp_f32 v139, v139
    v_exp_f32 v140, v140
    v_exp_f32 v141, v141
    v_smfmac_f32_32x32x32_bf16 v[192:207], v[48:51], v[128:135], v56
    s_cmp_eq_u32 s30, 0
    s_cbranch_scc1 L_pub
L_pub_ret:
    v_exp_f32 v142, v142
    v_exp_f32 v143, v143
    v_exp_f32 v144, v144
    v_exp_f32 v145, v145
    v_smfmac_f32_32x32x32_bf16 v[192:207], v[52:55], v[136:143], v56
    v_exp_f32 v146, v146
    v_exp_f32 v147, v147
    v_exp_f32 v148, v148
    v_exp_f32 v149, v149
    v_mfma_f32_32x32x16_bf16 v[160:175], v[44:47], v[8:11], v[160:175]
    v_exp_f32 v150, v150
    v_exp_f32 v151, v151
    v_exp_f32 v152, v152
    v_exp_f32 v153, v153
    v_smfmac_f32_32x32x32_bf16 v[208:223], v[48:51], v[144:151], v56
    v_exp_f32 v154, v154
    v_exp_f32 v155, v155
    v_exp_f32 v156, v156
    v_exp_f32 v157, v157
    v_mfma_f32_32x32x16_bf16 v[176:191], v[44:47], v[12:15], v[176:191]
    v_exp_f32 v158, v158
    v_exp_f32 v159, v159
    v_exp_f32 v160, v160
    v_exp_f32 v161, v161
    v_smfmac_f32_32x32x32_bf16 v[208:223], v[52:55], v[152:159], v56
    ds_read_b128 v[44:47], v57 offset:1024
    v_exp_f32 v162, v162
    v_exp_f32 v163, v163
    v_exp_f32 v164, v164
    v_exp_f32 v165, v165
    v_mfma_f32_32x32x4_2b_bf16 v[128:159], v[42:43], v[40:41], v[224:255] cbsz:1 abid:1
    v_exp_f32 v166, v166
    v_exp_f32 v167, v167
    v_exp_f32 v168, v168
    v_exp_f32 v169, v169
    v_exp_f32 v170, v170
    v_exp_f32 v171, v171
    v_exp_f32 v172, v172
    v_exp_f32 v173, v173
    v_smfmac_f32_32x32x32_bf16 v[96:111], v[48:51], v[160:167], v56
    s_mov_b64 exec, s[50:51]
    ds_read_b128 v[20:23], v59 offset:1280
    ds_read_b128 v[60:63], v59 offset:1920
    s_mov_b64 exec, -1
    v_exp_f32 v174, v174
    v_exp_f32 v175, v175
    v_exp_f32 v176, v176
    v_exp_f32 v177, v177
    v_smfmac_f32_32x32x32_bf16 v[96:111], v[52:55], v[168:175], v56
    s_waitcnt lgkmcnt(2)
    v_exp_f32 v178, v178
    v_exp_f32 v179, v179
    v_exp_f32 v180, v180
    v_exp_f32 v181, v181
    v_mfma_f32_32x32x16_bf16 v[128:143], v[44:47], v[32:35], v[128:143]
    v_exp_f32 v182, v182
    v_exp_f32 v183, v183
    v_exp_f32 v184, v184
    v_exp_f32 v185, v185
    v_smfmac_f32_32x32x32_bf16 v[112:127], v[48:51], v[176:183], v56
    v_exp_f32 v186, v186
    v_exp_f32 v187, v187
    v_exp_f32 v188, v188
    v_exp_f32 v189, v189
    v_mfma_f32_32x32x16_bf16 v[144:159], v[44:47], v[36:39], v[144:159]
    v_exp_f32 v190, v190
    v_exp_f32 v191, v191
    v_exp_f32 v128, v128
    v_exp_f32 v129, v129
    v_smfmac_f32_32x32x32_bf16 v[112:127], v[52:55], v[184:191], v56
    s_waitcnt lgkmcnt(0)
    v_exp_f32 v130, v130
    v_exp_f32 v131, v131
    v_exp_f32 v132, v132
    v_exp_f32 v133, v133
    v_mfma_f32_32x32x4_2b_bf16 v[160:191], v[42:43], v[16:17], v[64:95] cbsz:1 abid:1
    v_exp_f32 v134, v134
    v_exp_f32 v135, v135
    v_exp_f32 v136, v136
    v_exp_f32 v137, v137
    v_exp_f32 v138, v138
    v_exp_f32 v139, v139
    v_exp_f32 v140, v140
    v_exp_f32 v141, v141
    v_smfmac_f32_32x32x32_bf16 v[192:207], v[20:23], v[128:135], v56
    v_exp_f32 v142, v142
    v_exp_f32 v143, v143
    v_exp_f32 v144, v144
    v_exp_f32 v145, v145
    v_smfmac_f32_32x32x32_bf16 v[192:207], v[60:63], v[136:143], v56
    ds_read_b64 v[42:43], v58 offset:5120
    v_exp_f32 v146, v146
    v_exp_f32 v147, v147
    v_exp_f32 v148, v148
    v_exp_f32 v149, v149
    v_mfma_f32_32x32x16_bf16 v[160:175], v[44:47], v[8:11], v[160:175]
    v_exp_f32 v150, v150
    v_exp_f32 v151, v151
    v_exp_f32 v152, v152
    v_exp_f32 v153, v153
    v_smfmac_f32_32x32x32_bf16 v[208:223], v[20:23], v[144:151], v56
    v_exp_f32 v154, v154
    v_exp_f32 v155, v155
    v_exp_f32 v156, v156
    v_exp_f32 v157, v157
    v_mfma_f32_32x32x16_bf16 v[176:191], v[44:47], v[12:15], v[176:191]
    v_exp_f32 v158, v158
    v_exp_f32 v159, v159
    v_exp_f32 v160, v160
    v_exp_f32 v161, v161
    v_smfmac_f32_32x32x32_bf16 v[208:223], v[60:63], v[152:159], v56
    s_waitcnt lgkmcnt(0)
    ds_read_b128 v[44:47], v57 offset:5120
    v_exp_f32 v162, v162
    v_exp_f32 v163, v163
    v_exp_f32 v164, v164
    v_exp_f32 v165, v165
    v_mfma_f32_32x32x4_2b_bf16 v[128:159], v[42:43], v[40:41], v[224:255] cbsz:1 abid:0
    v_exp_f32 v166, v166
    v_exp_f32 v167, v167
    v_exp_f32 v168, v168
    v_exp_f32 v169, v169
    v_exp_f32 v170, v170
    v_exp_f32 v171, v171
    v_exp_f32 v172, v172
    v_exp_f32 v173, v173
    v_smfmac_f32_32x32x32_bf16 v[96:111], v[20:23], v[160:167], v56
    s_mov_b64 exec, s[50:51]
    ds_read_b128 v[48:51], v59 offset:5120
    ds_read_b128 v[52:55], v59 offset:5760
    s_mov_b64 exec, -1
    v_exp_f32 v174, v174
    v_exp_f32 v175, v175
    v_exp_f32 v176, v176
    v_exp_f32 v177, v177
    v_smfmac_f32_32x32x32_bf16 v[96:111], v[60:63], v[168:175], v56
    s_waitcnt lgkmcnt(2)
    v_exp_f32 v178, v178
    v_exp_f32 v179, v179
    v_exp_f32 v180, v180
    v_exp_f32 v181, v181
    v_mfma_f32_32x32x16_bf16 v[128:143], v[44:47], v[32:35], v[128:143]
    v_exp_f32 v182, v182
    v_exp_f32 v183, v183
    v_exp_f32 v184, v184
    v_exp_f32 v185, v185
    v_smfmac_f32_32x32x32_bf16 v[112:127], v[20:23], v[176:183], v56
    v_exp_f32 v186, v186
    v_exp_f32 v187, v187
    v_exp_f32 v188, v188
    v_exp_f32 v189, v189
    v_mfma_f32_32x32x16_bf16 v[144:159], v[44:47], v[36:39], v[144:159]
    v_exp_f32 v190, v190
    v_exp_f32 v191, v191
    v_exp_f32 v128, v128
    v_exp_f32 v129, v129
    v_smfmac_f32_32x32x32_bf16 v[112:127], v[60:63], v[184:191], v56
    s_waitcnt lgkmcnt(0)
    v_exp_f32 v130, v130
    v_exp_f32 v131, v131
    v_exp_f32 v132, v132
    v_exp_f32 v133, v133
    v_mfma_f32_32x32x4_2b_bf16 v[160:191], v[42:43], v[16:17], v[64:95] cbsz:1 abid:0
    v_exp_f32 v134, v134
    v_exp_f32 v135, v135
    v_exp_f32 v136, v136
    v_exp_f32 v137, v137
    v_exp_f32 v138, v138
    v_exp_f32 v139, v139
    v_exp_f32 v140, v140
    v_exp_f32 v141, v141
    v_smfmac_f32_32x32x32_bf16 v[192:207], v[48:51], v[128:135], v56
    v_exp_f32 v142, v142
    v_exp_f32 v143, v143
    v_exp_f32 v144, v144
    v_exp_f32 v145, v145
    v_smfmac_f32_32x32x32_bf16 v[192:207], v[52:55], v[136:143], v56
    v_exp_f32 v146, v146
    v_exp_f32 v147, v147
    v_exp_f32 v148, v148
    v_exp_f32 v149, v149
    v_mfma_f32_32x32x16_bf16 v[160:175], v[44:47], v[8:11], v[160:175]
    v_exp_f32 v150, v150
    v_exp_f32 v151, v151
    v_exp_f32 v152, v152
    v_exp_f32 v153, v153
    v_smfmac_f32_32x32x32_bf16 v[208:223], v[48:51], v[144:151], v56
    v_exp_f32 v154, v154
    v_exp_f32 v155, v155
    v_exp_f32 v156, v156
    v_exp_f32 v157, v157
    v_mfma_f32_32x32x16_bf16 v[176:191], v[44:47], v[12:15], v[176:191]
    v_exp_f32 v158, v158
    v_exp_f32 v159, v159
    v_exp_f32 v160, v160
    v_exp_f32 v161, v161
    v_smfmac_f32_32x32x32_bf16 v[208:223], v[52:55], v[152:159], v56
    ds_read_b128 v[44:47], v57 offset:6144
    v_exp_f32 v162, v162
    v_exp_f32 v163, v163
    v_exp_f32 v164, v164
    v_exp_f32 v165, v165
    v_mfma_f32_32x32x4_2b_bf16 v[128:159], v[42:43], v[40:41], v[224:255] cbsz:1 abid:1
    v_exp_f32 v166, v166
    v_exp_f32 v167, v167
    v_exp_f32 v168, v168
    v_exp_f32 v169, v169
    v_exp_f32 v170, v170
    v_exp_f32 v171, v171
    v_exp_f32 v172, v172
    v_exp_f32 v173, v173
    v_smfmac_f32_32x32x32_bf16 v[96:111], v[48:51], v[160:167], v56
    s_mov_b64 exec, s[50:51]
    ds_read_b128 v[20:23], v59 offset:6400
    ds_read_b128 v[60:63], v59 offset:7040
    s_mov_b64 exec, -1
    v_exp_f32 v174, v174
    v_exp_f32 v175, v175
    v_exp_f32 v176, v176
    v_exp_f32 v177, v177
    v_smfmac_f32_32x32x32_bf16 v[96:111], v[52:55], v[168:175], v56
    s_waitcnt lgkmcnt(2)
    v_exp_f32 v178, v178
    v_exp_f32 v179, v179
    v_exp_f32 v180, v180
    v_exp_f32 v181, v181
    v_mfma_f32_32x32x16_bf16 v[128:143], v[44:47], v[32:35], v[128:143]
    v_exp_f32 v182, v182
    v_exp_f32 v183, v183
    v_exp_f32 v184, v184
    v_exp_f32 v185, v185
    v_smfmac_f32_32x32x32_bf16 v[112:127], v[48:51], v[176:183], v56
    v_exp_f32 v186, v186
    v_exp_f32 v187, v187
    v_exp_f32 v188, v188
    v_exp_f32 v189, v189
    v_mfma_f32_32x32x16_bf16 v[144:159], v[44:47], v[36:39], v[144:159]
    v_exp_f32 v190, v190
    v_exp_f32 v191, v191
    v_exp_f32 v128, v128
    v_exp_f32 v129, v129
    v_smfmac_f32_32x32x32_bf16 v[112:127], v[52:55], v[184:191], v56
    s_waitcnt lgkmcnt(0)
    v_exp_f32 v130, v130
    v_exp_f32 v131, v131
    v_exp_f32 v132, v132
    v_exp_f32 v133, v133
    v_mfma_f32_32x32x4_2b_bf16 v[160:191], v[42:43], v[16:17], v[64:95] cbsz:1 abid:1
    v_exp_f32 v134, v134
    v_exp_f32 v135, v135
    v_exp_f32 v136, v136
    v_exp_f32 v137, v137
    v_exp_f32 v138, v138
    v_exp_f32 v139, v139
    v_exp_f32 v140, v140
    v_exp_f32 v141, v141
    v_smfmac_f32_32x32x32_bf16 v[192:207], v[20:23], v[128:135], v56
    v_exp_f32 v142, v142
    v_exp_f32 v143, v143
    v_exp_f32 v144, v144
    v_exp_f32 v145, v145
    v_smfmac_f32_32x32x32_bf16 v[192:207], v[60:63], v[136:143], v56
    ds_read_b64 v[42:43], v58 offset:10240
    v_exp_f32 v146, v146
    v_exp_f32 v147, v147
    v_exp_f32 v148, v148
    v_exp_f32 v149, v149
    v_mfma_f32_32x32x16_bf16 v[160:175], v[44:47], v[8:11], v[160:175]
    v_exp_f32 v150, v150
    v_exp_f32 v151, v151
    v_exp_f32 v152, v152
    v_exp_f32 v153, v153
    v_smfmac_f32_32x32x32_bf16 v[208:223], v[20:23], v[144:151], v56
    v_exp_f32 v154, v154
    v_exp_f32 v155, v155
    v_exp_f32 v156, v156
    v_exp_f32 v157, v157
    v_mfma_f32_32x32x16_bf16 v[176:191], v[44:47], v[12:15], v[176:191]
    v_exp_f32 v158, v158
    v_exp_f32 v159, v159
    v_exp_f32 v160, v160
    v_exp_f32 v161, v161
    v_smfmac_f32_32x32x32_bf16 v[208:223], v[60:63], v[152:159], v56
    s_waitcnt lgkmcnt(0)
    ds_read_b128 v[44:47], v57 offset:10240
    v_exp_f32 v162, v162
    v_exp_f32 v163, v163
    v_exp_f32 v164, v164
    v_exp_f32 v165, v165
    v_mfma_f32_32x32x4_2b_bf16 v[128:159], v[42:43], v[40:41], v[224:255] cbsz:1 abid:0
    v_exp_f32 v166, v166
    v_exp_f32 v167, v167
    v_exp_f32 v168, v168
    v_exp_f32 v169, v169
    v_exp_f32 v170, v170
    v_exp_f32 v171, v171
    v_exp_f32 v172, v172
    v_exp_f32 v173, v173
    v_smfmac_f32_32x32x32_bf16 v[96:111], v[20:23], v[160:167], v56
    s_mov_b64 exec, s[50:51]
    ds_read_b128 v[48:51], v59 offset:10240
    ds_read_b128 v[52:55], v59 offset:10880
    s_mov_b64 exec, -1
    v_exp_f32 v174, v174
    v_exp_f32 v175, v175
    v_exp_f32 v176, v176
    v_exp_f32 v177, v177
    v_smfmac_f32_32x32x32_bf16 v[96:111], v[60:63], v[168:175], v56
    s_waitcnt lgkmcnt(2)
    v_exp_f32 v178, v178
    v_exp_f32 v179, v179
    v_exp_f32 v180, v180
    v_exp_f32 v181, v181
    v_mfma_f32_32x32x16_bf16 v[128:143], v[44:47], v[32:35], v[128:143]
    v_exp_f32 v182, v182
    v_exp_f32 v183, v183
    v_exp_f32 v184, v184
    v_exp_f32 v185, v185
    v_smfmac_f32_32x32x32_bf16 v[112:127], v[20:23], v[176:183], v56
    v_exp_f32 v186, v186
    v_exp_f32 v187, v187
    v_exp_f32 v188, v188
    v_exp_f32 v189, v189
    v_mfma_f32_32x32x16_bf16 v[144:159], v[44:47], v[36:39], v[144:159]
    v_exp_f32 v190, v190
    v_exp_f32 v191, v191
    v_exp_f32 v128, v128
    v_exp_f32 v129, v129
    v_smfmac_f32_32x32x32_bf16 v[112:127], v[60:63], v[184:191], v56
    s_waitcnt lgkmcnt(0)
    v_exp_f32 v130, v130
    v_exp_f32 v131, v131
    v_exp_f32 v132, v132
    v_exp_f32 v133, v133
    v_mfma_f32_32x32x4_2b_bf16 v[160:191], v[42:43], v[16:17], v[64:95] cbsz:1 abid:0
    v_exp_f32 v134, v134
    v_exp_f32 v135, v135
    v_exp_f32 v136, v136
    v_exp_f32 v137, v137
    v_exp_f32 v138, v138
    v_exp_f32 v139, v139
    v_exp_f32 v140, v140
    v_exp_f32 v141, v141
    v_smfmac_f32_32x32x32_bf16 v[192:207], v[48:51], v[128:135], v56
    v_exp_f32 v142, v142
    v_exp_f32 v143, v143
    v_exp_f32 v144, v144
    v_exp_f32 v145, v145
    v_smfmac_f32_32x32x32_bf16 v[192:207], v[52:55], v[136:143], v56
    v_exp_f32 v146, v146
    v_exp_f32 v147, v147
    v_exp_f32 v148, v148
    v_exp_f32 v149, v149
    v_mfma_f32_32x32x16_bf16 v[160:175], v[44:47], v[8:11], v[160:175]
    v_exp_f32 v150, v150
    v_exp_f32 v151, v151
    v_exp_f32 v152, v152
    v_exp_f32 v153, v153
    v_smfmac_f32_32x32x32_bf16 v[208:223], v[48:51], v[144:151], v56
    v_exp_f32 v154, v154
    v_exp_f32 v155, v155
    v_exp_f32 v156, v156
    v_exp_f32 v157, v157
    v_mfma_f32_32x32x16_bf16 v[176:191], v[44:47], v[12:15], v[176:191]
    v_exp_f32 v158, v158
    v_exp_f32 v159, v159
    v_exp_f32 v160, v160
    v_exp_f32 v161, v161
    v_smfmac_f32_32x32x32_bf16 v[208:223], v[52:55], v[152:159], v56
    ds_read_b128 v[44:47], v57 offset:11264
    v_exp_f32 v162, v162
    v_exp_f32 v163, v163
    v_exp_f32 v164, v164
    v_exp_f32 v165, v165
    v_mfma_f32_32x32x4_2b_bf16 v[128:159], v[42:43], v[40:41], v[224:255] cbsz:1 abid:1
    v_exp_f32 v166, v166
    v_exp_f32 v167, v167
    v_exp_f32 v168, v168
    v_exp_f32 v169, v169
    v_exp_f32 v170, v170
    v_exp_f32 v171, v171
    v_exp_f32 v172, v172
    v_exp_f32 v173, v173
    v_smfmac_f32_32x32x32_bf16 v[96:111], v[48:51], v[160:167], v56
    s_mov_b64 exec, s[50:51]
    ds_read_b128 v[20:23], v59 offset:11520
    ds_read_b128 v[60:63], v59 offset:12160
    s_mov_b64 exec, -1
    v_exp_f32 v174, v174
    v_exp_f32 v175, v175
    v_exp_f32 v176, v176
    v_exp_f32 v177, v177
    v_smfmac_f32_32x32x32_bf16 v[96:111], v[52:55], v[168:175], v56
    s_waitcnt lgkmcnt(2)
    v_exp_f32 v178, v178
    v_exp_f32 v179, v179
    v_exp_f32 v180, v180
    v_exp_f32 v181, v181
    v_mfma_f32_32x32x16_bf16 v[128:143], v[44:47], v[32:35], v[128:143]
    v_exp_f32 v182, v182
    v_exp_f32 v183, v183
    v_exp_f32 v184, v184
    v_exp_f32 v185, v185
    v_smfmac_f32_32x32x32_bf16 v[112:127], v[48:51], v[176:183], v56
    v_exp_f32 v186, v186
    v_exp_f32 v187, v187
    v_exp_f32 v188, v188
    v_exp_f32 v189, v189
    v_mfma_f32_32x32x16_bf16 v[144:159], v[44:47], v[36:39], v[144:159]
    v_exp_f32 v190, v190
    v_exp_f32 v191, v191
    v_exp_f32 v128, v128
    v_exp_f32 v129, v129
    v_smfmac_f32_32x32x32_bf16 v[112:127], v[52:55], v[184:191], v56
    s_waitcnt lgkmcnt(0)
    v_exp_f32 v130, v130
    v_exp_f32 v131, v131
    v_exp_f32 v132, v132
    v_exp_f32 v133, v133
    v_mfma_f32_32x32x4_2b_bf16 v[160:191], v[42:43], v[16:17], v[64:95] cbsz:1 abid:1
    v_exp_f32 v134, v134
    v_exp_f32 v135, v135
    v_exp_f32 v136, v136
    v_exp_f32 v137, v137
    v_exp_f32 v138, v138
    v_exp_f32 v139, v139
    v_exp_f32 v140, v140
    v_exp_f32 v141, v141
    v_smfmac_f32_32x32x32_bf16 v[192:207], v[20:23], v[128:135], v56
    v_exp_f32 v142, v142
    v_exp_f32 v143, v143
    v_exp_f32 v144, v144
    v_exp_f32 v145, v145
    v_smfmac_f32_32x32x32_bf16 v[192:207], v[60:63], v[136:143], v56
    ds_read_b64 v[42:43], v58 offset:15360
    v_exp_f32 v146, v146
    v_exp_f32 v147, v147
    v_exp_f32 v148, v148
    v_exp_f32 v149, v149
    v_mfma_f32_32x32x16_bf16 v[160:175], v[44:47], v[8:11], v[160:175]
    v_exp_f32 v150, v150
    v_exp_f32 v151, v151
    v_exp_f32 v152, v152
    v_exp_f32 v153, v153
    v_smfmac_f32_32x32x32_bf16 v[208:223], v[20:23], v[144:151], v56
    v_exp_f32 v154, v154
    v_exp_f32 v155, v155
    v_exp_f32 v156, v156
    v_exp_f32 v157, v157
    v_mfma_f32_32x32x16_bf16 v[176:191], v[44:47], v[12:15], v[176:191]
    v_exp_f32 v158, v158
    v_exp_f32 v159, v159
    v_exp_f32 v160, v160
    v_exp_f32 v161, v161
    v_smfmac_f32_32x32x32_bf16 v[208:223], v[60:63], v[152:159], v56
    s_waitcnt lgkmcnt(0)
    ds_read_b128 v[44:47], v57 offset:15360
    v_exp_f32 v162, v162
    v_exp_f32 v163, v163
    v_exp_f32 v164, v164
    v_exp_f32 v165, v165
    v_mfma_f32_32x32x4_2b_bf16 v[128:159], v[42:43], v[40:41], v[224:255] cbsz:1 abid:0
    v_exp_f32 v166, v166
    v_exp_f32 v167, v167
    v_exp_f32 v168, v168
    v_exp_f32 v169, v169
    v_exp_f32 v170, v170
    v_exp_f32 v171, v171
    v_exp_f32 v172, v172
    v_exp_f32 v173, v173
    v_smfmac_f32_32x32x32_bf16 v[96:111], v[20:23], v[160:167], v56
    s_mov_b64 exec, s[50:51]
    ds_read_b128 v[48:51], v59 offset:15360
    ds_read_b128 v[52:55], v59 offset:16000
    s_mov_b64 exec, -1
    v_exp_f32 v174, v174
    v_exp_f32 v175, v175
    v_exp_f32 v176, v176
    v_exp_f32 v177, v177
    v_smfmac_f32_32x32x32_bf16 v[96:111], v[60:63], v[168:175], v56
    s_waitcnt lgkmcnt(2)
    v_exp_f32 v178, v178
    v_exp_f32 v179, v179
    v_exp_f32 v180, v180
    v_exp_f32 v181, v181
    v_mfma_f32_32x32x16_bf16 v[128:143], v[44:47], v[32:35], v[128:143]
    v_exp_f32 v182, v182
    v_exp_f32 v183, v183
    v_exp_f32 v184, v184
    v_exp_f32 v185, v185
    v_smfmac_f32_32x32x32_bf16 v[112:127], v[20:23], v[176:183], v56
    v_exp_f32 v186, v186
    v_exp_f32 v187, v187
    v_exp_f32 v188, v188
    v_exp_f32 v189, v189
    v_mfma_f32_32x32x16_bf16 v[144:159], v[44:47], v[36:39], v[144:159]
    v_exp_f32 v190, v190
    v_exp_f32 v191, v191
    v_exp_f32 v128, v128
    v_exp_f32 v129, v129
    v_smfmac_f32_32x32x32_bf16 v[112:127], v[60:63], v[184:191], v56
    s_waitcnt lgkmcnt(0)
    v_exp_f32 v130, v130
    v_exp_f32 v131, v131
    v_exp_f32 v132, v132
    v_exp_f32 v133, v133
    v_mfma_f32_32x32x4_2b_bf16 v[160:191], v[42:43], v[16:17], v[64:95] cbsz:1 abid:0
    v_exp_f32 v134, v134
    v_exp_f32 v135, v135
    v_exp_f32 v136, v136
    v_exp_f32 v137, v137
    v_exp_f32 v138, v138
    v_exp_f32 v139, v139
    v_exp_f32 v140, v140
    v_exp_f32 v141, v141
    v_smfmac_f32_32x32x32_bf16 v[192:207], v[48:51], v[128:135], v56
    s_cmp_eq_u32 s31, 98304
    s_cselect_b32 s32, -98304, s63
    v_exp_f32 v142, v142
    v_exp_f32 v143, v143
    v_exp_f32 v144, v144
    v_exp_f32 v145, v145
    v_smfmac_f32_32x32x32_bf16 v[192:207], v[52:55], v[136:143], v56
    s_add_u32 s31, s31, s32
    v_exp_f32 v146, v146
    v_exp_f32 v147, v147
    v_exp_f32 v148, v148
    v_exp_f32 v149, v149
    v_mfma_f32_32x32x16_bf16 v[160:175], v[44:47], v[8:11], v[160:175]
    v_exp_f32 v150, v150
    v_exp_f32 v151, v151
    v_exp_f32 v152, v152
    v_exp_f32 v153, v153
    v_smfmac_f32_32x32x32_bf16 v[208:223], v[48:51], v[144:151], v56
    v_exp_f32 v154, v154
    v_exp_f32 v155, v155
    v_exp_f32 v156, v156
    v_exp_f32 v157, v157
    v_mfma_f32_32x32x16_bf16 v[176:191], v[44:47], v[12:15], v[176:191]
    v_exp_f32 v158, v158
    v_exp_f32 v159, v159
    v_exp_f32 v160, v160
    v_exp_f32 v161, v161
    v_smfmac_f32_32x32x32_bf16 v[208:223], v[52:55], v[152:159], v56
    ds_read_b128 v[44:47], v57 offset:16384
    v_exp_f32 v162, v162
    v_exp_f32 v163, v163
    v_exp_f32 v164, v164
    v_exp_f32 v165, v165
    v_mfma_f32_32x32x4_2b_bf16 v[128:159], v[42:43], v[40:41], v[224:255] cbsz:1 abid:1
    v_exp_f32 v166, v166
    v_exp_f32 v167, v167
    v_exp_f32 v168, v168
    v_exp_f32 v169, v169
    v_exp_f32 v170, v170
    v_exp_f32 v171, v171
    v_exp_f32 v172, v172
    v_exp_f32 v173, v173
    v_smfmac_f32_32x32x32_bf16 v[96:111], v[48:51], v[160:167], v56
    s_mov_b64 exec, s[50:51]
    ds_read_b128 v[20:23], v59 offset:16640
    ds_read_b128 v[60:63], v59 offset:17280
    s_mov_b64 exec, -1
    v_exp_f32 v174, v174
    v_exp_f32 v175, v175
    v_exp_f32 v176, v176
    v_exp_f32 v177, v177
    v_smfmac_f32_32x32x32_bf16 v[96:111], v[52:55], v[168:175], v56
    s_waitcnt lgkmcnt(2)
    v_exp_f32 v178, v178
    v_exp_f32 v179, v179
    v_exp_f32 v180, v180
    v_exp_f32 v181, v181
    v_mfma_f32_32x32x16_bf16 v[128:143], v[44:47], v[32:35], v[128:143]
    v_exp_f32 v182, v182
    v_exp_f32 v183, v183
    v_exp_f32 v184, v184
    v_exp_f32 v185, v185
    v_smfmac_f32_32x32x32_bf16 v[112:127], v[48:51], v[176:183], v56
    v_exp_f32 v186, v186
    v_exp_f32 v187, v187
    v_exp_f32 v188, v188
    v_exp_f32 v189, v189
    v_mfma_f32_32x32x16_bf16 v[144:159], v[44:47], v[36:39], v[144:159]
    v_exp_f32 v190, v190
    v_exp_f32 v191, v191
    v_exp_f32 v128, v128
    v_exp_f32 v129, v129
    v_smfmac_f32_32x32x32_bf16 v[112:127], v[52:55], v[184:191], v56
    s_waitcnt lgkmcnt(0)
    v_exp_f32 v130, v130
    v_exp_f32 v131, v131
    v_exp_f32 v132, v132
    v_exp_f32 v133, v133
    v_mfma_f32_32x32x4_2b_bf16 v[160:191], v[42:43], v[16:17], v[64:95] cbsz:1 abid:1
    v_exp_f32 v134, v134
    v_exp_f32 v135, v135
    v_exp_f32 v136, v136
    v_exp_f32 v137, v137
    v_add_u32 v57, s32, v57
    v_add_u32 v58, s32, v58
    v_add_u32 v59, s32, v59
    v_exp_f32 v138, v138
    v_exp_f32 v139, v139
    v_exp_f32 v140, v140
    v_exp_f32 v141, v141
    v_smfmac_f32_32x32x32_bf16 v[192:207], v[20:23], v[128:135], v56
    s_barrier
    v_exp_f32 v142, v142
    v_exp_f32 v143, v143
    v_exp_f32 v144, v144
    v_exp_f32 v145, v145
    v_smfmac_f32_32x32x32_bf16 v[192:207], v[60:63], v[136:143], v56
    ds_read_b64 v[42:43], v58 offset:0
    v_exp_f32 v146, v146
    v_exp_f32 v147, v147
    v_exp_f32 v148, v148
    v_exp_f32 v149, v149
    v_mfma_f32_32x32x16_bf16 v[160:175], v[44:47], v[8:11], v[160:175]
    v_exp_f32 v150, v150
    v_exp_f32 v151, v151
    v_exp_f32 v152, v152
    v_exp_f32 v153, v153
    v_smfmac_f32_32x32x32_bf16 v[208:223], v[20:23], v[144:151], v56
    v_exp_f32 v154, v154
    v_exp_f32 v155, v155
    v_exp_f32 v156, v156
    v_exp_f32 v157, v157
    v_mfma_f32_32x32x16_bf16 v[176:191], v[44:47], v[12:15], v[176:191]
    v_exp_f32 v158, v158
    v_exp_f32 v159, v159
    v_exp_f32 v160, v160
    v_exp_f32 v161, v161
    v_smfmac_f32_32x32x32_bf16 v[208:223], v[60:63], v[152:159], v56
    s_waitcnt lgkmcnt(0)
    ds_read_b128 v[44:47], v57 offset:0
    v_exp_f32 v162, v162
    v_exp_f32 v163, v163
    v_exp_f32 v164, v164
    v_exp_f32 v165, v165
    v_mfma_f32_32x32x4_2b_bf16 v[128:159], v[42:43], v[40:41], v[224:255] cbsz:1 abid:0
    v_exp_f32 v166, v166
    v_exp_f32 v167, v167
    v_exp_f32 v168, v168
    v_exp_f32 v169, v169
    v_exp_f32 v170, v170
    v_exp_f32 v171, v171
    v_exp_f32 v172, v172
    v_exp_f32 v173, v173
    v_smfmac_f32_32x32x32_bf16 v[96:111], v[20:23], v[160:167], v56
    s_mov_b64 exec, s[50:51]
    ds_read_b128 v[48:51], v59 offset:0
    ds_read_b128 v[52:55], v59 offset:640
    s_mov_b64 exec, -1
    v_exp_f32 v174, v174
    v_exp_f32 v175, v175
    v_exp_f32 v176, v176
    v_exp_f32 v177, v177
    v_smfmac_f32_32x32x32_bf16 v[96:111], v[60:63], v[168:175], v56
    s_waitcnt lgkmcnt(2)
    v_exp_f32 v178, v178
    v_exp_f32 v179, v179
    v_exp_f32 v180, v180
    v_exp_f32 v181, v181
    v_mfma_f32_32x32x16_bf16 v[128:143], v[44:47], v[32:35], v[128:143]
    v_exp_f32 v182, v182
    v_exp_f32 v183, v183
    v_exp_f32 v184, v184
    v_exp_f32 v185, v185
    v_smfmac_f32_32x32x32_bf16 v[112:127], v[20:23], v[176:183], v56
    s_add_u32 s30, s30, 1
    s_cmp_lt_u32 s30, 8
    v_exp_f32 v186, v186
    v_exp_f32 v187, v187
    v_exp_f32 v188, v188
    v_exp_f32 v189, v189
    v_mfma_f32_32x32x16_bf16 v[144:159], v[44:47], v[36:39], v[144:159]
    v_exp_f32 v190, v190
    v_exp_f32 v191, v191
    s_cbranch_scc1 L_attn
L_attn_done:
    s_setprio 0
    v_smfmac_f32_32x32x32_bf16 v[112:127], v[60:63], v[184:191], v56
    s_mov_b32 s30, 0
L_fin:
    v_mov_b32 v2, v200
    v_mov_b32 v3, v200
    s_mov_b32 s36, 0
    s_mov_b32 s37, 41216
    v_permlane32_swap_b32 v2, v3
    v_rcp_f32 v2, v3
    v_mov_b32 v4, v216
    v_mov_b32 v5, v216
    v_pk_mul_f32 v[176:177], v[192:193], v[2:3] op_sel_hi:[1,0]
    v_pk_mul_f32 v[178:179], v[194:195], v[2:3] op_sel_hi:[1,0]
    v_pk_mul_f32 v[180:181], v[196:197], v[2:3] op_sel_hi:[1,0]
    v_pk_mul_f32 v[182:183], v[198:199], v[2:3] op_sel_hi:[1,0]
    v_pk_mul_f32 v[184:185], v[200:201], v[2:3] op_sel_hi:[1,0]
    v_pk_mul_f32 v[186:187], v[202:203], v[2:3] op_sel_hi:[1,0]
    v_cvt_pk_bf16_f32 v160, v176, v177
    v_cvt_pk_bf16_f32 v161, v178, v179
    v_cvt_pk_bf16_f32 v162, v180, v181
    v_cvt_pk_bf16_f32 v163, v182, v183
    v_permlane32_swap_b32 v4, v5
    buffer_store_dwordx4 v[160:163], v25, s[16:19], s36 offen sc1
    v_rcp_f32 v4, v5
    v_cvt_pk_bf16_f32 v164, v184, v185
    v_cvt_pk_bf16_f32 v165, v186, v187
    v_pk_mul_f32 v[176:177], v[208:209], v[4:5] op_sel_hi:[1,0]
    v_pk_mul_f32 v[178:179], v[210:211], v[4:5] op_sel_hi:[1,0]
    v_pk_mul_f32 v[180:181], v[212:213], v[4:5] op_sel_hi:[1,0]
    v_pk_mul_f32 v[182:183], v[214:215], v[4:5] op_sel_hi:[1,0]
    v_pk_mul_f32 v[184:185], v[216:217], v[4:5] op_sel_hi:[1,0]
    v_pk_mul_f32 v[186:187], v[218:219], v[4:5] op_sel_hi:[1,0]
    v_cvt_pk_bf16_f32 v172, v184, v185
    v_cvt_pk_bf16_f32 v173, v186, v187
    v_cvt_pk_bf16_f32 v168, v176, v177
    v_cvt_pk_bf16_f32 v169, v178, v179
    v_cvt_pk_bf16_f32 v170, v180, v181
    v_cvt_pk_bf16_f32 v171, v182, v183
    buffer_store_dwordx4 v[168:171], v25, s[16:19], s37 offen sc1
    v_permlane32_swap_b32 v164, v172
    v_permlane32_swap_b32 v165, v173
    buffer_store_dwordx2 v[164:165], v26, s[16:19], s36 offen sc1
    v_mov_b32 v60, v104
    v_mov_b32 v61, v104
    s_mov_b32 s36, 82432
    s_mov_b32 s37, 123648
    v_permlane32_swap_b32 v60, v61
    v_rcp_f32 v60, v61
    v_mov_b32 v62, v120
    v_mov_b32 v63, v120
    v_pk_mul_f32 v[240:241], v[96:97], v[60:61] op_sel_hi:[1,0]
    v_pk_mul_f32 v[242:243], v[98:99], v[60:61] op_sel_hi:[1,0]
    v_pk_mul_f32 v[244:245], v[100:101], v[60:61] op_sel_hi:[1,0]
    v_pk_mul_f32 v[246:247], v[102:103], v[60:61] op_sel_hi:[1,0]
    v_pk_mul_f32 v[248:249], v[104:105], v[60:61] op_sel_hi:[1,0]
    v_pk_mul_f32 v[250:251], v[106:107], v[60:61] op_sel_hi:[1,0]
    v_cvt_pk_bf16_f32 v224, v240, v241
    v_cvt_pk_bf16_f32 v225, v242, v243
    v_cvt_pk_bf16_f32 v226, v244, v245
    v_cvt_pk_bf16_f32 v227, v246, v247
    v_permlane32_swap_b32 v62, v63
    buffer_store_dwordx4 v[224:227], v25, s[16:19], s36 offen sc1
    v_rcp_f32 v62, v63
    v_cvt_pk_bf16_f32 v228, v248, v249
    v_cvt_pk_bf16_f32 v229, v250, v251
    v_pk_mul_f32 v[240:241], v[112:113], v[62:63] op_sel_hi:[1,0]
    v_pk_mul_f32 v[242:243], v[114:115], v[62:63] op_sel_hi:[1,0]
    v_pk_mul_f32 v[244:245], v[116:117], v[62:63] op_sel_hi:[1,0]
    v_pk_mul_f32 v[246:247], v[118:119], v[62:63] op_sel_hi:[1,0]
    v_pk_mul_f32 v[248:249], v[120:121], v[62:63] op_sel_hi:[1,0]
    v_pk_mul_f32 v[250:251], v[122:123], v[62:63] op_sel_hi:[1,0]
    v_cvt_pk_bf16_f32 v236, v248, v249
    v_cvt_pk_bf16_f32 v237, v250, v251
    v_cvt_pk_bf16_f32 v232, v240, v241
    v_cvt_pk_bf16_f32 v233, v242, v243
    v_cvt_pk_bf16_f32 v234, v244, v245
    v_cvt_pk_bf16_f32 v235, v246, v247
    buffer_store_dwordx4 v[232:235], v25, s[16:19], s37 offen sc1
    v_permlane32_swap_b32 v228, v236
    v_permlane32_swap_b32 v229, v237
    buffer_store_dwordx2 v[228:229], v26, s[16:19], s36 offen sc1
    v_mov_b64 v[6:7], 0
    v_pk_fma_f32 v[6:7], v[192:193], 0, v[6:7] op_sel_hi:[1,0,1]
    v_pk_fma_f32 v[6:7], v[194:195], 0, v[6:7] op_sel_hi:[1,0,1]
    v_pk_fma_f32 v[6:7], v[196:197], 0, v[6:7] op_sel_hi:[1,0,1]
    v_pk_fma_f32 v[6:7], v[198:199], 0, v[6:7] op_sel_hi:[1,0,1]
    v_pk_fma_f32 v[6:7], v[200:201], 0, v[6:7] op_sel_hi:[1,0,1]
    v_pk_fma_f32 v[6:7], v[202:203], 0, v[6:7] op_sel_hi:[1,0,1]
    v_pk_fma_f32 v[6:7], v[208:209], 0, v[6:7] op_sel_hi:[1,0,1]
    v_pk_fma_f32 v[6:7], v[210:211], 0, v[6:7] op_sel_hi:[1,0,1]
    v_pk_fma_f32 v[6:7], v[212:213], 0, v[6:7] op_sel_hi:[1,0,1]
    v_pk_fma_f32 v[6:7], v[214:215], 0, v[6:7] op_sel_hi:[1,0,1]
    v_pk_fma_f32 v[6:7], v[216:217], 0, v[6:7] op_sel_hi:[1,0,1]
    v_pk_fma_f32 v[6:7], v[218:219], 0, v[6:7] op_sel_hi:[1,0,1]
    v_pk_fma_f32 v[6:7], v[96:97], 0, v[6:7] op_sel_hi:[1,0,1]
    v_pk_fma_f32 v[6:7], v[98:99], 0, v[6:7] op_sel_hi:[1,0,1]
    v_pk_fma_f32 v[6:7], v[100:101], 0, v[6:7] op_sel_hi:[1,0,1]
    v_pk_fma_f32 v[6:7], v[102:103], 0, v[6:7] op_sel_hi:[1,0,1]
    v_pk_fma_f32 v[6:7], v[104:105], 0, v[6:7] op_sel_hi:[1,0,1]
    v_pk_fma_f32 v[6:7], v[106:107], 0, v[6:7] op_sel_hi:[1,0,1]
    v_pk_fma_f32 v[6:7], v[112:113], 0, v[6:7] op_sel_hi:[1,0,1]
    v_pk_fma_f32 v[6:7], v[114:115], 0, v[6:7] op_sel_hi:[1,0,1]
    v_pk_fma_f32 v[6:7], v[116:117], 0, v[6:7] op_sel_hi:[1,0,1]
    v_pk_fma_f32 v[6:7], v[118:119], 0, v[6:7] op_sel_hi:[1,0,1]
    v_pk_fma_f32 v[6:7], v[120:121], 0, v[6:7] op_sel_hi:[1,0,1]
    v_pk_fma_f32 v[6:7], v[122:123], 0, v[6:7] op_sel_hi:[1,0,1]
    v_max3_f32 v2, v3, v5, v61
    v_min3_f32 v4, v3, v5, v61
    v_add_f32 v6, v6, v7
    v_max_f32 v2, v2, v63
    v_min_f32 v4, v4, v63
    v_add_f32 v2, v2, v6
    v_cmp_nle_f32 s[54:55], 1.0, v4
    v_cmp_nge_f32 vcc, 0x7b800000, v2
    s_nop 1
    s_or_b64 vcc, vcc, s[54:55]
    s_cmp_eq_u32 s30, 0
    s_cselect_b64 s[56:57], -1, 0
    s_and_b64 s[56:57], s[56:57], vcc
    s_cbranch_scc1 L_slow
L_tail:
    v_and_b32 v2, 15, v1
    v_lshlrev_b32 v2, 13, v2
    v_bfe_u32 v3, v1, 4, 1
    v_lshl_add_u32 v13, v3, 8, v2
    s_lshl_b32 s36, s24, 7
    s_add_u32 s36, s36, s26
    s_lshl_b32 s36, s36, 3
    s_lshr_b32 s37, s25, 3
    s_add_u32 s36, s36, s37
    s_lshl_b32 s30, s36, 7
    s_lshl_b32 s52, 0x10001, s25
    s_not_b32 s52, s52
    s_mov_b32 s53, 0
    v_lshrrev_b32 v2, 4, v1
    v_lshrrev_b32 v3, 5, v1
    v_bfe_u32 v4, v1, 2, 3
    v_and_b32 v5, 3, v1
    s_mov_b32 s36, 49152
    v_lshl_add_u32 v5, v5, 3, s36
    v_mul_u32_u24 v4, 160, v4
    v_add_u32 v5, v5, v4
    v_mul_u32_u24 v4, 3840, v3
    v_add_u32 v8, v5, v4
    v_mul_u32_u24 v4, 12800, v3
    v_add_u32 v4, 2560, v4
    v_add_u32 v10, v5, v4
    v_add_u32 v9, 51200, v8
    v_add_u32 v14, 51200, v10
    s_lshl_b32 s46, s26, 1
    s_add_u32 s46, s46, s37
    s_lshl_b32 s46, s46, 3
    s_add_u32 s46, s46, s27
    v_lshlrev_b32 v11, 4, v1
    v_lshlrev_b32 v12, 3, v1
    s_mul_i32 s32, s46, 20608
    s_add_u32 s33, s32, 4096
    s_add_u32 s34, s32, 8192
    s_add_u32 s35, s32, 12288
    s_add_u32 s74, s32, 16384
    ds_read_b64_tr_b16 v[76:77], v8 offset:0
    ds_read_b64_tr_b16 v[78:79], v8 offset:1280
    ds_read_b64_tr_b16 v[80:81], v8 offset:32
    ds_read_b64_tr_b16 v[82:83], v8 offset:1312
    ds_read_b64_tr_b16 v[84:85], v8 offset:64
    ds_read_b64_tr_b16 v[86:87], v8 offset:1344
    ds_read_b64_tr_b16 v[88:89], v8 offset:96
    ds_read_b64_tr_b16 v[90:91], v8 offset:1376
    ds_read_b64_tr_b16 v[92:93], v8 offset:128
    ds_read_b64_tr_b16 v[94:95], v8 offset:1408
    ds_read_b64_tr_b16 v[96:97], v8 offset:6400
    ds_read_b64_tr_b16 v[98:99], v8 offset:7680
    ds_read_b64_tr_b16 v[100:101], v8 offset:6432
    ds_read_b64_tr_b16 v[102:103], v8 offset:7712
    ds_read_b64_tr_b16 v[104:105], v8 offset:6464
    ds_read_b64_tr_b16 v[106:107], v8 offset:7744
    ds_read_b64_tr_b16 v[108:109], v8 offset:6496
    ds_read_b64_tr_b16 v[110:111], v8 offset:7776
    ds_read_b64_tr_b16 v[112:113], v8 offset:6528
    ds_read_b64_tr_b16 v[114:115], v8 offset:7808
    ds_read_b64_tr_b16 v[116:117], v8 offset:12800
    ds_read_b64_tr_b16 v[118:119], v8 offset:14080
    ds_read_b64_tr_b16 v[120:121], v8 offset:12832
    ds_read_b64_tr_b16 v[122:123], v8 offset:14112
    ds_read_b64_tr_b16 v[124:125], v8 offset:12864
    ds_read_b64_tr_b16 v[126:127], v8 offset:14144
    ds_read_b64_tr_b16 v[128:129], v8 offset:12896
    ds_read_b64_tr_b16 v[130:131], v8 offset:14176
    ds_read_b64_tr_b16 v[132:133], v8 offset:12928
    ds_read_b64_tr_b16 v[134:135], v8 offset:14208
    v_mov_b32 v3, 2
    s_waitcnt vmcnt(0)
    s_cmp_ge_u32 s27, 4
    s_cbranch_scc1 L_noflag
    s_mov_b64 exec, 1
    buffer_store_dword v3, v28, s[20:23], s41 offen sc1
    s_mov_b64 exec, -1
L_noflag:
    ds_read_b64_tr_b16 v[136:137], v8 offset:19200
    ds_read_b64_tr_b16 v[138:139], v8 offset:20480
    ds_read_b64_tr_b16 v[140:141], v8 offset:19232
    ds_read_b64_tr_b16 v[142:143], v8 offset:20512
    ds_read_b64_tr_b16 v[144:145], v8 offset:19264
    ds_read_b64_tr_b16 v[146:147], v8 offset:20544
    ds_read_b64_tr_b16 v[148:149], v8 offset:19296
    ds_read_b64_tr_b16 v[150:151], v8 offset:20576
    ds_read_b64_tr_b16 v[152:153], v8 offset:19328
    ds_read_b64_tr_b16 v[154:155], v8 offset:20608
    ds_read_b64_tr_b16 v[156:157], v8 offset:25600
    ds_read_b64_tr_b16 v[158:159], v8 offset:26880
    ds_read_b64_tr_b16 v[160:161], v8 offset:25632
    ds_read_b64_tr_b16 v[162:163], v8 offset:26912
    ds_read_b64_tr_b16 v[164:165], v8 offset:25664
    ds_read_b64_tr_b16 v[166:167], v8 offset:26944
    ds_read_b64_tr_b16 v[168:169], v8 offset:25696
    ds_read_b64_tr_b16 v[170:171], v8 offset:26976
    ds_read_b64_tr_b16 v[172:173], v8 offset:25728
    ds_read_b64_tr_b16 v[174:175], v8 offset:27008
    ds_read_b64_tr_b16 v[176:177], v8 offset:32000
    ds_read_b64_tr_b16 v[178:179], v8 offset:33280
    ds_read_b64_tr_b16 v[180:181], v8 offset:32032
    ds_read_b64_tr_b16 v[182:183], v8 offset:33312
    ds_read_b64_tr_b16 v[184:185], v8 offset:32064
    ds_read_b64_tr_b16 v[186:187], v8 offset:33344
    ds_read_b64_tr_b16 v[188:189], v8 offset:32096
    ds_read_b64_tr_b16 v[190:191], v8 offset:33376
    ds_read_b64_tr_b16 v[192:193], v8 offset:32128
    ds_read_b64_tr_b16 v[194:195], v8 offset:33408
    ds_read_b64_tr_b16 v[196:197], v8 offset:38400
    ds_read_b64_tr_b16 v[198:199], v8 offset:39680
    ds_read_b64_tr_b16 v[200:201], v8 offset:38432
    ds_read_b64_tr_b16 v[202:203], v8 offset:39712
    ds_read_b64_tr_b16 v[204:205], v8 offset:38464
    ds_read_b64_tr_b16 v[206:207], v8 offset:39744
    ds_read_b64_tr_b16 v[208:209], v8 offset:38496
    ds_read_b64_tr_b16 v[210:211], v8 offset:39776
    ds_read_b64_tr_b16 v[212:213], v8 offset:38528
    ds_read_b64_tr_b16 v[214:215], v8 offset:39808
    ds_read_b64_tr_b16 v[216:217], v8 offset:44800
    ds_read_b64_tr_b16 v[218:219], v8 offset:46080
    ds_read_b64_tr_b16 v[220:221], v8 offset:44832
    ds_read_b64_tr_b16 v[222:223], v8 offset:46112
    ds_read_b64_tr_b16 v[224:225], v8 offset:44864
    ds_read_b64_tr_b16 v[226:227], v8 offset:46144
    ds_read_b64_tr_b16 v[228:229], v8 offset:44896
    ds_read_b64_tr_b16 v[230:231], v8 offset:46176
    ds_read_b64_tr_b16 v[232:233], v8 offset:44928
    ds_read_b64_tr_b16 v[234:235], v8 offset:46208
    ds_read_b64_tr_b16 v[236:237], v9 offset:0
    ds_read_b64_tr_b16 v[238:239], v9 offset:1280
    ds_read_b64_tr_b16 v[240:241], v9 offset:32
    ds_read_b64_tr_b16 v[242:243], v9 offset:1312
    ds_read_b64_tr_b16 v[244:245], v9 offset:64
    ds_read_b64_tr_b16 v[246:247], v9 offset:1344
    ds_read_b64_tr_b16 v[248:249], v9 offset:96
    ds_read_b64_tr_b16 v[250:251], v9 offset:1376
    ds_read_b64_tr_b16 v[252:253], v9 offset:128
    ds_read_b64_tr_b16 v[254:255], v9 offset:1408
    s_cmp_eq_u32 s27, 4
    s_cbranch_scc0 L_ogot
    buffer_load_dword v27, v13, s[20:23], s30 offen sc1
L_ospin:
    s_waitcnt vmcnt(0)
    v_cmp_ne_u32 vcc, 2, v27
    s_sub_u32 s47, s47, 1
    s_cmp_le_i32 s47, 0
    s_cbranch_scc1 L_ogot
    s_and_b64 s[52:53], s[52:53], vcc
    s_cbranch_scc0 L_ogot
    s_mov_b64 exec, s[52:53]
    s_sleep 3
    buffer_load_dword v27, v13, s[20:23], s30 offen sc1
    s_branch L_ospin
L_ogot:
    s_mov_b64 exec, -1
    s_barrier
    buffer_load_dwordx4 v[32:35], v11, s[16:19], s32 offen offset:0 sc1
    buffer_load_dwordx4 v[36:39], v11, s[16:19], s32 offen offset:1024 sc1
    buffer_load_dwordx4 v[40:43], v11, s[16:19], s32 offen offset:2048 sc1
    buffer_load_dwordx4 v[44:47], v11, s[16:19], s32 offen offset:3072 sc1
    buffer_load_dwordx4 v[48:51], v11, s[16:19], s33 offen offset:0 sc1
    buffer_load_dwordx4 v[52:55], v11, s[16:19], s33 offen offset:1024 sc1
    s_mul_i32 s37, s27, 3072
    v_add_u32 v15, s37, v11
    v_and_b32 v5, 15, v1
    v_mul_u32_u24 v5, 160, v5
    v_lshl_add_u32 v5, v2, 3, v5
    v_add_u32 v16, s37, v5
    s_lshl_b32 s46, s46, 4
    s_mul_i32 s46, s46, 2560
    s_mul_i32 s36, s24, 1280
    s_add_u32 s46, s46, s36
    s_and_b32 s36, s25, 7
    s_mul_i32 s36, s36, 160
    s_add_u32 s46, s46, s36
    s_mov_b32 s4, s80
    s_mov_b32 s5, s81
    s_mov_b32 s6, 5242880
    s_mov_b32 s7, 0x20000
    v_add_u32 v3, 0, v1
    v_mul_u32_u24 v4, 6554, v3
    v_lshrrev_b32 v4, 16, v4
    v_mul_u32_u24 v4, 2400, v4
    v_lshl_add_u32 v18, v3, 4, v4
    v_add_u32 v3, 64, v1
    v_mul_u32_u24 v4, 6554, v3
    v_lshrrev_b32 v4, 16, v4
    v_mul_u32_u24 v4, 2400, v4
    v_lshl_add_u32 v19, v3, 4, v4
    v_add_u32 v3, 128, v1
    v_mul_u32_u24 v4, 6554, v3
    v_lshrrev_b32 v4, 16, v4
    v_mul_u32_u24 v4, 2400, v4
    v_lshl_add_u32 v20, v3, 4, v4
    v_mov_b32 v3, 0x80000000
    v_cndmask_b32 v20, v20, v3, s[42:43]
    s_setprio 3
    s_waitcnt vmcnt(5) lgkmcnt(0)
    v_mfma_f32_16x16x32_bf16 v[56:59], v[76:79], v[32:35], 0
    v_mfma_f32_16x16x32_bf16 v[60:63], v[80:83], v[32:35], 0
    v_mfma_f32_16x16x32_bf16 v[64:67], v[84:87], v[32:35], 0
    v_mfma_f32_16x16x32_bf16 v[68:71], v[88:91], v[32:35], 0
    v_mfma_f32_16x16x32_bf16 v[72:75], v[92:95], v[32:35], 0
    buffer_load_dwordx4 v[32:35], v11, s[16:19], s33 offen offset:2048 sc1
    s_waitcnt vmcnt(5)
    v_mfma_f32_16x16x32_bf16 v[56:59], v[96:99], v[36:39], v[56:59]
    ds_read_b64_tr_b16 v[76:77], v9 offset:6400
    ds_read_b64_tr_b16 v[78:79], v9 offset:7680
    v_mfma_f32_16x16x32_bf16 v[60:63], v[100:103], v[36:39], v[60:63]
    ds_read_b64_tr_b16 v[80:81], v9 offset:6432
    ds_read_b64_tr_b16 v[82:83], v9 offset:7712
    v_mfma_f32_16x16x32_bf16 v[64:67], v[104:107], v[36:39], v[64:67]
    ds_read_b64_tr_b16 v[84:85], v9 offset:6464
    v_mfma_f32_16x16x32_bf16 v[68:71], v[108:111], v[36:39], v[68:71]
    ds_read_b64_tr_b16 v[86:87], v9 offset:7744
    v_mfma_f32_16x16x32_bf16 v[72:75], v[112:115], v[36:39], v[72:75]
    ds_read_b64_tr_b16 v[88:89], v9 offset:6496
    buffer_load_dwordx4 v[36:39], v11, s[16:19], s33 offen offset:3072 sc1
    s_waitcnt vmcnt(5)
    v_mfma_f32_16x16x32_bf16 v[56:59], v[116:119], v[40:43], v[56:59]
    ds_read_b64_tr_b16 v[90:91], v9 offset:7776
    ds_read_b64_tr_b16 v[92:93], v9 offset:6528
    v_mfma_f32_16x16x32_bf16 v[60:63], v[120:123], v[40:43], v[60:63]
    ds_read_b64_tr_b16 v[94:95], v9 offset:7808
    ds_read_b64_tr_b16 v[96:97], v9 offset:12800
    v_mfma_f32_16x16x32_bf16 v[64:67], v[124:127], v[40:43], v[64:67]
    ds_read_b64_tr_b16 v[98:99], v9 offset:14080
    v_mfma_f32_16x16x32_bf16 v[68:71], v[128:131], v[40:43], v[68:71]
    ds_read_b64_tr_b16 v[100:101], v9 offset:12832
    v_mfma_f32_16x16x32_bf16 v[72:75], v[132:135], v[40:43], v[72:75]
    ds_read_b64_tr_b16 v[102:103], v9 offset:14112
    buffer_load_dwordx4 v[40:43], v11, s[16:19], s34 offen offset:0 sc1
    s_waitcnt vmcnt(5)
    v_mfma_f32_16x16x32_bf16 v[56:59], v[136:139], v[44:47], v[56:59]
    ds_read_b64_tr_b16 v[104:105], v9 offset:12864
    ds_read_b64_tr_b16 v[106:107], v9 offset:14144
    v_mfma_f32_16x16x32_bf16 v[60:63], v[140:143], v[44:47], v[60:63]
    ds_read_b64_tr_b16 v[108:109], v9 offset:12896
    ds_read_b64_tr_b16 v[110:111], v9 offset:14176
    v_mfma_f32_16x16x32_bf16 v[64:67], v[144:147], v[44:47], v[64:67]
    ds_read_b64_tr_b16 v[112:113], v9 offset:12928
    v_mfma_f32_16x16x32_bf16 v[68:71], v[148:151], v[44:47], v[68:71]
    ds_read_b64_tr_b16 v[114:115], v9 offset:14208
    v_mfma_f32_16x16x32_bf16 v[72:75], v[152:155], v[44:47], v[72:75]
    ds_read_b64_tr_b16 v[116:117], v9 offset:19200
    buffer_load_dwordx4 v[44:47], v11, s[16:19], s34 offen offset:1024 sc1
    s_waitcnt vmcnt(5)
    v_mfma_f32_16x16x32_bf16 v[56:59], v[156:159], v[48:51], v[56:59]
    ds_read_b64_tr_b16 v[118:119], v9 offset:20480
    ds_read_b64_tr_b16 v[120:121], v9 offset:19232
    v_mfma_f32_16x16x32_bf16 v[60:63], v[160:163], v[48:51], v[60:63]
    ds_read_b64_tr_b16 v[122:123], v9 offset:20512
    ds_read_b64_tr_b16 v[124:125], v9 offset:19264
    v_mfma_f32_16x16x32_bf16 v[64:67], v[164:167], v[48:51], v[64:67]
    ds_read_b64_tr_b16 v[126:127], v9 offset:20544
    v_mfma_f32_16x16x32_bf16 v[68:71], v[168:171], v[48:51], v[68:71]
    ds_read_b64_tr_b16 v[128:129], v9 offset:19296
    v_mfma_f32_16x16x32_bf16 v[72:75], v[172:175], v[48:51], v[72:75]
    ds_read_b64_tr_b16 v[130:131], v9 offset:20576
    buffer_load_dwordx4 v[48:51], v11, s[16:19], s34 offen offset:2048 sc1
    s_waitcnt vmcnt(5)
    v_mfma_f32_16x16x32_bf16 v[56:59], v[176:179], v[52:55], v[56:59]
    ds_read_b64_tr_b16 v[132:133], v9 offset:19328
    ds_read_b64_tr_b16 v[134:135], v9 offset:20608
    v_mfma_f32_16x16x32_bf16 v[60:63], v[180:183], v[52:55], v[60:63]
    ds_read_b64_tr_b16 v[136:137], v9 offset:25600
    ds_read_b64_tr_b16 v[138:139], v9 offset:26880
    v_mfma_f32_16x16x32_bf16 v[64:67], v[184:187], v[52:55], v[64:67]
    ds_read_b64_tr_b16 v[140:141], v9 offset:25632
    v_mfma_f32_16x16x32_bf16 v[68:71], v[188:191], v[52:55], v[68:71]
    ds_read_b64_tr_b16 v[142:143], v9 offset:26912
    v_mfma_f32_16x16x32_bf16 v[72:75], v[192:195], v[52:55], v[72:75]
    ds_read_b64_tr_b16 v[144:145], v9 offset:25664
    buffer_load_dwordx4 v[52:55], v11, s[16:19], s34 offen offset:3072 sc1
    s_setprio 2
    s_waitcnt vmcnt(5)
    v_mfma_f32_16x16x32_bf16 v[56:59], v[196:199], v[32:35], v[56:59]
    ds_read_b64_tr_b16 v[146:147], v9 offset:26944
    ds_read_b64_tr_b16 v[148:149], v9 offset:25696
    v_mfma_f32_16x16x32_bf16 v[60:63], v[200:203], v[32:35], v[60:63]
    ds_read_b64_tr_b16 v[150:151], v9 offset:26976
    ds_read_b64_tr_b16 v[152:153], v9 offset:25728
    v_mfma_f32_16x16x32_bf16 v[64:67], v[204:207], v[32:35], v[64:67]
    ds_read_b64_tr_b16 v[154:155], v9 offset:27008
    v_mfma_f32_16x16x32_bf16 v[68:71], v[208:211], v[32:35], v[68:71]
    ds_read_b64_tr_b16 v[156:157], v9 offset:32000
    v_mfma_f32_16x16x32_bf16 v[72:75], v[212:215], v[32:35], v[72:75]
    ds_read_b64_tr_b16 v[158:159], v9 offset:33280
    buffer_load_dwordx4 v[32:35], v11, s[16:19], s35 offen offset:0 sc1
    s_waitcnt vmcnt(5)
    v_mfma_f32_16x16x32_bf16 v[56:59], v[216:219], v[36:39], v[56:59]
    ds_read_b64_tr_b16 v[160:161], v9 offset:32032
    ds_read_b64_tr_b16 v[162:163], v9 offset:33312
    v_mfma_f32_16x16x32_bf16 v[60:63], v[220:223], v[36:39], v[60:63]
    ds_read_b64_tr_b16 v[164:165], v9 offset:32064
    ds_read_b64_tr_b16 v[166:167], v9 offset:33344
    v_mfma_f32_16x16x32_bf16 v[64:67], v[224:227], v[36:39], v[64:67]
    ds_read_b64_tr_b16 v[168:169], v9 offset:32096
    v_mfma_f32_16x16x32_bf16 v[68:71], v[228:231], v[36:39], v[68:71]
    ds_read_b64_tr_b16 v[170:171], v9 offset:33376
    v_mfma_f32_16x16x32_bf16 v[72:75], v[232:235], v[36:39], v[72:75]
    ds_read_b64_tr_b16 v[172:173], v9 offset:32128
    buffer_load_dwordx4 v[36:39], v11, s[16:19], s35 offen offset:1024 sc1
    s_waitcnt vmcnt(5)
    v_mfma_f32_16x16x32_bf16 v[56:59], v[236:239], v[40:43], v[56:59]
    ds_read_b64_tr_b16 v[174:175], v9 offset:33408
    ds_read_b64_tr_b16 v[176:177], v9 offset:38400
    v_mfma_f32_16x16x32_bf16 v[60:63], v[240:243], v[40:43], v[60:63]
    ds_read_b64_tr_b16 v[178:179], v9 offset:39680
    ds_read_b64_tr_b16 v[180:181], v9 offset:38432
    v_mfma_f32_16x16x32_bf16 v[64:67], v[244:247], v[40:43], v[64:67]
    ds_read_b64_tr_b16 v[182:183], v9 offset:39712
    v_mfma_f32_16x16x32_bf16 v[68:71], v[248:251], v[40:43], v[68:71]
    ds_read_b64_tr_b16 v[184:185], v9 offset:38464
    v_mfma_f32_16x16x32_bf16 v[72:75], v[252:255], v[40:43], v[72:75]
    ds_read_b64_tr_b16 v[186:187], v9 offset:39744
    buffer_load_dwordx4 v[40:43], v11, s[16:19], s35 offen offset:2048 sc1
    s_waitcnt vmcnt(5) lgkmcnt(14)
    v_mfma_f32_16x16x32_bf16 v[56:59], v[76:79], v[44:47], v[56:59]
    ds_read_b64_tr_b16 v[188:189], v9 offset:38496
    ds_read_b64_tr_b16 v[190:191], v9 offset:39776
    v_mfma_f32_16x16x32_bf16 v[60:63], v[80:83], v[44:47], v[60:63]
    ds_read_b64_tr_b16 v[192:193], v9 offset:38528
    ds_read_b64_tr_b16 v[194:195], v9 offset:39808
    v_mfma_f32_16x16x32_bf16 v[64:67], v[84:87], v[44:47], v[64:67]
    ds_read_b64_tr_b16 v[196:197], v9 offset:44800
    v_mfma_f32_16x16x32_bf16 v[68:71], v[88:91], v[44:47], v[68:71]
    ds_read_b64_tr_b16 v[198:199], v9 offset:46080
    v_mfma_f32_16x16x32_bf16 v[72:75], v[92:95], v[44:47], v[72:75]
    ds_read_b64_tr_b16 v[200:201], v9 offset:44832
    buffer_load_dwordx4 v[44:47], v11, s[16:19], s35 offen offset:3072 sc1
    s_waitcnt vmcnt(5) lgkmcnt(14)
    v_mfma_f32_16x16x32_bf16 v[56:59], v[96:99], v[48:51], v[56:59]
    ds_read_b64_tr_b16 v[202:203], v9 offset:46112
    ds_read_b64_tr_b16 v[204:205], v9 offset:44864
    v_mfma_f32_16x16x32_bf16 v[60:63], v[100:103], v[48:51], v[60:63]
    ds_read_b64_tr_b16 v[206:207], v9 offset:46144
    ds_read_b64_tr_b16 v[208:209], v9 offset:44896
    v_mfma_f32_16x16x32_bf16 v[64:67], v[104:107], v[48:51], v[64:67]
    ds_read_b64_tr_b16 v[210:211], v9 offset:46176
    v_mfma_f32_16x16x32_bf16 v[68:71], v[108:111], v[48:51], v[68:71]
    ds_read_b64_tr_b16 v[212:213], v9 offset:44928
    v_mfma_f32_16x16x32_bf16 v[72:75], v[112:115], v[48:51], v[72:75]
    ds_read_b64_tr_b16 v[214:215], v9 offset:46208
    buffer_load_dwordx2 v[48:49], v12, s[16:19], s74 offen offset:0 sc1
    buffer_load_dwordx2 v[50:51], v12, s[16:19], s74 offen offset:512 sc1
    s_waitcnt vmcnt(6) lgkmcnt(14)
    v_mfma_f32_16x16x32_bf16 v[56:59], v[116:119], v[52:55], v[56:59]
    ds_read_b64_tr_b16 v[216:217], v10 offset:0
    ds_read_b64_tr_b16 v[218:219], v10 offset:6400
    v_mfma_f32_16x16x32_bf16 v[60:63], v[120:123], v[52:55], v[60:63]
    ds_read_b64_tr_b16 v[220:221], v10 offset:32
    ds_read_b64_tr_b16 v[222:223], v10 offset:6432
    v_mfma_f32_16x16x32_bf16 v[64:67], v[124:127], v[52:55], v[64:67]
    ds_read_b64_tr_b16 v[224:225], v10 offset:64
    v_mfma_f32_16x16x32_bf16 v[68:71], v[128:131], v[52:55], v[68:71]
    ds_read_b64_tr_b16 v[226:227], v10 offset:6464
    v_mfma_f32_16x16x32_bf16 v[72:75], v[132:135], v[52:55], v[72:75]
    ds_read_b64_tr_b16 v[228:229], v10 offset:96
    buffer_load_dwordx2 v[52:53], v12, s[16:19], s74 offen offset:1024 sc1
    buffer_load_dwordx2 v[54:55], v12, s[16:19], s74 offen offset:1536 sc1
    s_setprio 1
    s_waitcnt vmcnt(7) lgkmcnt(14)
    v_mfma_f32_16x16x32_bf16 v[56:59], v[136:139], v[32:35], v[56:59]
    ds_read_b64_tr_b16 v[230:231], v10 offset:6496
    ds_read_b64_tr_b16 v[232:233], v10 offset:128
    v_mfma_f32_16x16x32_bf16 v[60:63], v[140:143], v[32:35], v[60:63]
    ds_read_b64_tr_b16 v[234:235], v10 offset:6528
    ds_read_b64_tr_b16 v[236:237], v10 offset:25600
    v_mfma_f32_16x16x32_bf16 v[64:67], v[144:147], v[32:35], v[64:67]
    ds_read_b64_tr_b16 v[238:239], v10 offset:32000
    v_mfma_f32_16x16x32_bf16 v[68:71], v[148:151], v[32:35], v[68:71]
    ds_read_b64_tr_b16 v[240:241], v10 offset:25632
    v_mfma_f32_16x16x32_bf16 v[72:75], v[152:155], v[32:35], v[72:75]
    ds_read_b64_tr_b16 v[242:243], v10 offset:32032
    buffer_load_dwordx2 v[32:33], v12, s[16:19], s74 offen offset:2048 sc1
    buffer_load_dwordx2 v[34:35], v12, s[16:19], s74 offen offset:2560 sc1
    s_waitcnt vmcnt(8) lgkmcnt(14)
    v_mfma_f32_16x16x32_bf16 v[56:59], v[156:159], v[36:39], v[56:59]
    ds_read_b64_tr_b16 v[244:245], v10 offset:25664
    ds_read_b64_tr_b16 v[246:247], v10 offset:32064
    v_mfma_f32_16x16x32_bf16 v[60:63], v[160:163], v[36:39], v[60:63]
    ds_read_b64_tr_b16 v[248:249], v10 offset:25696
    ds_read_b64_tr_b16 v[250:251], v10 offset:32096
    v_mfma_f32_16x16x32_bf16 v[64:67], v[164:167], v[36:39], v[64:67]
    ds_read_b64_tr_b16 v[252:253], v10 offset:25728
    v_mfma_f32_16x16x32_bf16 v[68:71], v[168:171], v[36:39], v[68:71]
    ds_read_b64_tr_b16 v[254:255], v10 offset:32128
    v_mfma_f32_16x16x32_bf16 v[72:75], v[172:175], v[36:39], v[72:75]
    ds_read_b64_tr_b16 v[76:77], v14 offset:0
    buffer_load_dwordx2 v[36:37], v12, s[16:19], s74 offen offset:3072 sc1
    buffer_load_dwordx2 v[38:39], v12, s[16:19], s74 offen offset:3584 sc1
    s_waitcnt vmcnt(9) lgkmcnt(14)
    v_mfma_f32_16x16x32_bf16 v[56:59], v[176:179], v[40:43], v[56:59]
    ds_read_b64_tr_b16 v[78:79], v14 offset:6400
    ds_read_b64_tr_b16 v[80:81], v14 offset:32
    v_mfma_f32_16x16x32_bf16 v[60:63], v[180:183], v[40:43], v[60:63]
    ds_read_b64_tr_b16 v[82:83], v14 offset:6432
    ds_read_b64_tr_b16 v[84:85], v14 offset:64
    v_mfma_f32_16x16x32_bf16 v[64:67], v[184:187], v[40:43], v[64:67]
    ds_read_b64_tr_b16 v[86:87], v14 offset:6464
    v_mfma_f32_16x16x32_bf16 v[68:71], v[188:191], v[40:43], v[68:71]
    ds_read_b64_tr_b16 v[88:89], v14 offset:96
    v_mfma_f32_16x16x32_bf16 v[72:75], v[192:195], v[40:43], v[72:75]
    ds_read_b64_tr_b16 v[90:91], v14 offset:6496
    s_waitcnt vmcnt(8) lgkmcnt(14)
    v_mfma_f32_16x16x32_bf16 v[56:59], v[196:199], v[44:47], v[56:59]
    ds_read_b64_tr_b16 v[92:93], v14 offset:128
    ds_read_b64_tr_b16 v[94:95], v14 offset:6528
    v_mfma_f32_16x16x32_bf16 v[60:63], v[200:203], v[44:47], v[60:63]
    ds_read_b64_tr_b16 v[96:97], v14 offset:25600
    ds_read_b64_tr_b16 v[98:99], v14 offset:32000
    v_mfma_f32_16x16x32_bf16 v[64:67], v[204:207], v[44:47], v[64:67]
    ds_read_b64_tr_b16 v[100:101], v14 offset:25632
    v_mfma_f32_16x16x32_bf16 v[68:71], v[208:211], v[44:47], v[68:71]
    ds_read_b64_tr_b16 v[102:103], v14 offset:32032
    v_mfma_f32_16x16x32_bf16 v[72:75], v[212:215], v[44:47], v[72:75]
    ds_read_b64_tr_b16 v[104:105], v14 offset:25664
    s_setprio 0
    s_waitcnt vmcnt(6) lgkmcnt(14)
    v_mfma_f32_16x16x32_bf16 v[56:59], v[216:219], v[48:51], v[56:59]
    ds_read_b64_tr_b16 v[106:107], v14 offset:32064
    v_mfma_f32_16x16x32_bf16 v[60:63], v[220:223], v[48:51], v[60:63]
    ds_read_b64_tr_b16 v[108:109], v14 offset:25696
    v_mfma_f32_16x16x32_bf16 v[64:67], v[224:227], v[48:51], v[64:67]
    ds_read_b64_tr_b16 v[110:111], v14 offset:32096
    v_mfma_f32_16x16x32_bf16 v[68:71], v[228:231], v[48:51], v[68:71]
    ds_read_b64_tr_b16 v[112:113], v14 offset:25728
    v_mfma_f32_16x16x32_bf16 v[72:75], v[232:235], v[48:51], v[72:75]
    ds_read_b64_tr_b16 v[114:115], v14 offset:32128
    s_waitcnt vmcnt(4) lgkmcnt(14)
    v_mfma_f32_16x16x32_bf16 v[56:59], v[236:239], v[52:55], v[56:59]
    v_mfma_f32_16x16x32_bf16 v[60:63], v[240:243], v[52:55], v[60:63]
    v_mfma_f32_16x16x32_bf16 v[64:67], v[244:247], v[52:55], v[64:67]
    v_mfma_f32_16x16x32_bf16 v[68:71], v[248:251], v[52:55], v[68:71]
    v_mfma_f32_16x16x32_bf16 v[72:75], v[252:255], v[52:55], v[72:75]
    s_waitcnt vmcnt(2) lgkmcnt(10)
    v_mfma_f32_16x16x32_bf16 v[56:59], v[76:79], v[32:35], v[56:59]
    v_mfma_f32_16x16x32_bf16 v[60:63], v[80:83], v[32:35], v[60:63]
    v_mfma_f32_16x16x32_bf16 v[64:67], v[84:87], v[32:35], v[64:67]
    v_mfma_f32_16x16x32_bf16 v[68:71], v[88:91], v[32:35], v[68:71]
    v_mfma_f32_16x16x32_bf16 v[72:75], v[92:95], v[32:35], v[72:75]
    s_waitcnt vmcnt(0) lgkmcnt(0)
    v_mfma_f32_16x16x32_bf16 v[56:59], v[96:99], v[36:39], v[56:59]
    v_mfma_f32_16x16x32_bf16 v[60:63], v[100:103], v[36:39], v[60:63]
    v_mfma_f32_16x16x32_bf16 v[64:67], v[104:107], v[36:39], v[64:67]
    v_mfma_f32_16x16x32_bf16 v[68:71], v[108:111], v[36:39], v[68:71]
    v_mfma_f32_16x16x32_bf16 v[72:75], v[112:115], v[36:39], v[72:75]
    s_nop 3
    v_cvt_pk_bf16_f32 v32, v56, v57
    v_cvt_pk_bf16_f32 v33, v58, v59
    ds_write_b64 v16, v[32:33] offset:0
    v_cvt_pk_bf16_f32 v34, v60, v61
    v_cvt_pk_bf16_f32 v35, v62, v63
    ds_write_b64 v16, v[34:35] offset:32
    v_cvt_pk_bf16_f32 v36, v64, v65
    v_cvt_pk_bf16_f32 v37, v66, v67
    ds_write_b64 v16, v[36:37] offset:64
    v_cvt_pk_bf16_f32 v38, v68, v69
    v_cvt_pk_bf16_f32 v39, v70, v71
    ds_write_b64 v16, v[38:39] offset:96
    v_cvt_pk_bf16_f32 v40, v72, v73
    v_cvt_pk_bf16_f32 v41, v74, v75
    ds_write_b64 v16, v[40:41] offset:128
    ds_read_b128 v[76:79], v15 offset:0
    ds_read_b128 v[80:83], v15 offset:1024
    ds_read_b128 v[84:87], v15 offset:2048
    s_waitcnt lgkmcnt(2)
    buffer_store_dwordx4 v[76:79], v18, s[4:7], s46 offen nt
    s_waitcnt lgkmcnt(1)
    buffer_store_dwordx4 v[80:83], v19, s[4:7], s46 offen nt
    s_waitcnt lgkmcnt(0)
    buffer_store_dwordx4 v[84:87], v20, s[4:7], s46 offen nt
L_end:
    s_endpgm
L_w7:
    s_cmp_eq_u32 s30, 2
    s_cbranch_scc0 L_w7b
    v_mov_b32 v3, 1
    s_mov_b64 exec, 1
    buffer_atomic_add v3, v28, s[88:91], 0 offen sc1
    s_mov_b64 exec, -1
    s_branch L_w7_ret
L_w7b:
    s_cmp_eq_u32 s30, 9
    s_cbranch_scc0 L_w7spin
    buffer_load_dword v27, v28, s[88:91], 0 offen sc1
    s_branch L_w7_ret
L_w7spin:
    s_waitcnt vmcnt(0)
    v_readfirstlane_b32 s36, v27
    s_sub_u32 s47, s47, 1
    s_cmp_le_i32 s47, 0
    s_cbranch_scc1 L_w7_ret
    s_cmp_ge_u32 s36, 128
    s_cbranch_scc1 L_w7_ret
    s_sleep 4
    buffer_load_dword v27, v28, s[88:91], 0 offen sc1
    s_branch L_w7spin
L_pub:
    s_waitcnt vmcnt(0)
    s_mov_b64 exec, 1
    buffer_store_dword v3, v28, s[20:23], s41 offen sc1
    s_mov_b64 exec, -1
    s_branch L_pub_ret
L_helper:
    s_setprio 3
    ds_write_b128 v78, v[32:35]
    ds_write_b128 v78, v[36:39] offset:1024
    ds_write_b128 v78, v[40:43] offset:2048
    v_mov_b32 v3, 1
    s_waitcnt lgkmcnt(0)
    s_barrier
    buffer_store_dwordx4 v[232:235], v95, s[12:15], s62 offen offset:0 sc1
    buffer_store_dwordx4 v[236:239], v95, s[12:15], s62 offen offset:1280 sc1
    s_sub_u32 s69, s69, 512
    s_mul_i32 s45, s72, 10240
    s_mov_b32 s31, 0
    s_mov_b32 s30, -1
    s_waitcnt vmcnt(0)
    s_mov_b64 exec, 1
    buffer_store_dword v3, v28, s[20:23], s41 offen sc1
    s_mov_b64 exec, -1
    s_waitcnt vmcnt(0)
L_hloop:
    s_and_b32 s40, s95, s92
    s_cbranch_scc1 L_hgo
L_hspin:
    buffer_load_dword v27, v24, s[20:23], s69 offen sc1
    s_waitcnt vmcnt(0)
    v_cmp_ne_u32 vcc, 0, v27
    s_sub_u32 s47, s47, 1
    s_nop 0
    s_lshr_b32 s95, vcc_lo, 8
    s_and_b32 s95, s95, vcc_lo
    s_cmp_le_i32 s47, 0
    s_cselect_b32 s95, -1, s95
    s_and_b32 s40, s95, s92
    s_cbranch_scc1 L_hgo
    s_sleep 4
    s_branch L_hspin
L_hgo:
    s_ff1_i32_b32 s40, s40
    s_bitset0_b32 s92, s40
    s_mul_i32 s62, s40, 49152
    s_add_u32 s63, s45, s31
    s_add_u32 m0, s63, 0
    s_add_u32 s62, s62, 0
    buffer_load_dwordx4 v77, s[12:15], s62 offen offset:0 sc1 lds
    buffer_load_dwordx4 v77, s[12:15], s62 offen offset:1024 sc1 lds
    buffer_load_dwordx4 v77, s[12:15], s62 offen offset:2048 sc1 lds
    buffer_load_dwordx4 v77, s[12:15], s62 offen offset:3072 sc1 lds
    s_add_u32 m0, s63, 4096
    s_add_u32 s62, s62, 4096
    buffer_load_dwordx4 v77, s[12:15], s62 offen offset:0 sc1 lds
    buffer_load_dwordx4 v77, s[12:15], s62 offen offset:1024 sc1 lds
    buffer_load_dwordx4 v77, s[12:15], s62 offen offset:2048 sc1 lds
    buffer_load_dwordx4 v77, s[12:15], s62 offen offset:3072 sc1 lds
    s_add_u32 m0, s63, 8192
    s_add_u32 s62, s62, 4096
    buffer_load_dwordx4 v77, s[12:15], s62 offen offset:0 sc1 lds
    buffer_load_dwordx4 v77, s[12:15], s62 offen offset:1024 sc1 lds
    s_add_u32 s31, s31, 49152
    s_cmp_eq_u32 s31, 147456
    s_cselect_b32 s31, 0, s31
    s_cmp_eq_u32 s30, 4
    s_cbranch_scc0 L_hnt
    s_lshl_b32 s36, s68, 2
    s_add_u32 s36, s36, s72
    s_mul_i32 s36, s36, 6400
    v_min_u32 v2, 49, v1
    v_lshlrev_b32 v2, 7, v2
    buffer_load_dword v3, v2, s[84:87], s36 offen
L_hnt:
    s_add_u32 s30, s30, 1
    s_waitcnt vmcnt(0)
    s_barrier
    s_cmp_lt_u32 s30, 6
    s_cbranch_scc1 L_hloop
    s_add_u32 s36, s72, 0
    s_mul_i32 s37, s36, 5120
    s_mul_i32 s36, s36, 40960
    s_add_u32 m0, s37, 49152
    s_nop 0
    buffer_load_dwordx4 v64, s[84:87], s36 offen lds
    s_add_u32 m0, s37, 50176
    s_nop 0
    buffer_load_dwordx4 v65, s[84:87], s36 offen lds
    s_add_u32 m0, s37, 51200
    s_nop 0
    buffer_load_dwordx4 v66, s[84:87], s36 offen lds
    s_add_u32 m0, s37, 52224
    s_nop 0
    buffer_load_dwordx4 v67, s[84:87], s36 offen lds
    s_add_u32 m0, s37, 53248
    s_nop 0
    buffer_load_dwordx4 v68, s[84:87], s36 offen lds
    s_add_u32 s36, s72, 4
    s_mul_i32 s37, s36, 5120
    s_mul_i32 s36, s36, 40960
    s_add_u32 m0, s37, 49152
    s_nop 0
    buffer_load_dwordx4 v64, s[84:87], s36 offen lds
    s_add_u32 m0, s37, 50176
    s_nop 0
    buffer_load_dwordx4 v65, s[84:87], s36 offen lds
    s_add_u32 m0, s37, 51200
    s_nop 0
    buffer_load_dwordx4 v66, s[84:87], s36 offen lds
    s_add_u32 m0, s37, 52224
    s_nop 0
    buffer_load_dwordx4 v67, s[84:87], s36 offen lds
    s_add_u32 m0, s37, 53248
    s_nop 0
    buffer_load_dwordx4 v68, s[84:87], s36 offen lds
    s_add_u32 s36, s72, 8
    s_mul_i32 s37, s36, 5120
    s_mul_i32 s36, s36, 40960
    s_add_u32 m0, s37, 49152
    s_nop 0
    buffer_load_dwordx4 v64, s[84:87], s36 offen lds
    s_add_u32 m0, s37, 50176
    s_nop 0
    buffer_load_dwordx4 v65, s[84:87], s36 offen lds
    s_add_u32 m0, s37, 51200
    s_nop 0
    buffer_load_dwordx4 v66, s[84:87], s36 offen lds
    s_add_u32 m0, s37, 52224
    s_nop 0
    buffer_load_dwordx4 v67, s[84:87], s36 offen lds
    s_add_u32 m0, s37, 53248
    s_nop 0
    buffer_load_dwordx4 v68, s[84:87], s36 offen lds
    s_add_u32 s36, s72, 12
    s_mul_i32 s37, s36, 5120
    s_mul_i32 s36, s36, 40960
    s_add_u32 m0, s37, 49152
    s_nop 0
    buffer_load_dwordx4 v64, s[84:87], s36 offen lds
    s_add_u32 m0, s37, 50176
    s_nop 0
    buffer_load_dwordx4 v65, s[84:87], s36 offen lds
    s_add_u32 m0, s37, 51200
    s_nop 0
    buffer_load_dwordx4 v66, s[84:87], s36 offen lds
    s_add_u32 m0, s37, 52224
    s_nop 0
    buffer_load_dwordx4 v67, s[84:87], s36 offen lds
    s_add_u32 m0, s37, 53248
    s_nop 0
    buffer_load_dwordx4 v68, s[84:87], s36 offen lds
    s_add_u32 s36, s72, 16
    s_mul_i32 s37, s36, 5120
    s_mul_i32 s36, s36, 40960
    s_add_u32 m0, s37, 49152
    s_nop 0
    buffer_load_dwordx4 v64, s[84:87], s36 offen lds
    s_add_u32 m0, s37, 50176
    s_nop 0
    buffer_load_dwordx4 v65, s[84:87], s36 offen lds
    s_add_u32 m0, s37, 51200
    s_nop 0
    buffer_load_dwordx4 v66, s[84:87], s36 offen lds
    s_add_u32 m0, s37, 52224
    s_nop 0
    buffer_load_dwordx4 v67, s[84:87], s36 offen lds
    s_add_u32 m0, s37, 53248
    s_nop 0
    buffer_load_dwordx4 v68, s[84:87], s36 offen lds
    s_waitcnt vmcnt(0)
    s_barrier
    s_setprio 0
    s_branch L_tail
L_code_end:
L_slow:
    s_waitcnt vmcnt(0) lgkmcnt(0)
    v_subrev_u32 v57, s31, v57
    v_subrev_u32 v58, s31, v58
    v_subrev_u32 v59, s31, v59
    v_mov_b32 v2, 0xff800000
    v_mov_b32 v3, 0xff800000
    s_mov_b32 s62, 0
L_slow_max0:
    s_lshr_b32 s63, s62, 3
    s_mul_i32 s63, s63, 49152
    s_bfe_u32 s36, s62, 0x20001
    s_mul_i32 s36, s36, 5120
    s_add_u32 s63, s63, s36
    s_and_b32 s36, s62, 1
    s_lshl_b32 s37, s36, 10
    s_add_u32 s37, s37, s63
    buffer_load_dwordx4 v[44:47], v57, s[12:15], s37 offen sc1
    s_lshl_b32 s37, s36, 8
    s_add_u32 s37, s37, s63
    buffer_load_dwordx2 v[42:43], v58, s[12:15], s37 offen sc1
    s_waitcnt vmcnt(0)
    v_mfma_f32_32x32x4_2b_bf16 v[128:159], v[42:43], v[40:41], 0 cbsz:1 abid:0
    s_nop 15
    s_nop 1
    v_mfma_f32_32x32x16_bf16 v[128:143], v[44:47], v[32:35], v[128:143]
    v_mfma_f32_32x32x16_bf16 v[144:159], v[44:47], v[36:39], v[144:159]
    s_nop 11
    v_max3_f32 v2, v2, v128, v129
    v_max3_f32 v2, v2, v130, v131
    v_max3_f32 v2, v2, v132, v133
    v_max3_f32 v2, v2, v134, v135
    v_max3_f32 v2, v2, v136, v137
    v_max3_f32 v2, v2, v138, v139
    v_max3_f32 v2, v2, v140, v141
    v_max3_f32 v2, v2, v142, v143
    v_max3_f32 v3, v3, v144, v145
    v_max3_f32 v3, v3, v146, v147
    v_max3_f32 v3, v3, v148, v149
    v_max3_f32 v3, v3, v150, v151
    v_max3_f32 v3, v3, v152, v153
    v_max3_f32 v3, v3, v154, v155
    v_max3_f32 v3, v3, v156, v157
    v_max3_f32 v3, v3, v158, v159
    s_add_u32 s62, s62, 1
    s_cmp_lt_u32 s62, 64
    s_cbranch_scc1 L_slow_max0
    v_sub_f32 v2, 0x0, v2
    v_sub_f32 v3, 0x0, v3
    v_mov_b32 v4, v2
    v_mov_b32 v5, v3
    s_nop 0
    v_permlane32_swap_b32 v2, v4
    v_permlane32_swap_b32 v3, v5
    v_min_f32 v42, v2, v4
    v_min_f32 v43, v3, v5
    v_mov_b32 v224, v42
    v_mov_b32 v225, v42
    v_mov_b32 v240, v43
    v_mov_b32 v241, v43
    v_mov_b64 v[226:227], v[224:225]
    v_mov_b64 v[242:243], v[240:241]
    v_mov_b64 v[228:229], v[224:225]
    v_mov_b64 v[244:245], v[240:241]
    v_mov_b64 v[230:231], v[224:225]
    v_mov_b64 v[246:247], v[240:241]
    v_mov_b64 v[232:233], v[224:225]
    v_mov_b64 v[248:249], v[240:241]
    v_mov_b64 v[234:235], v[224:225]
    v_mov_b64 v[250:251], v[240:241]
    v_mov_b64 v[236:237], v[224:225]
    v_mov_b64 v[252:253], v[240:241]
    v_mov_b64 v[238:239], v[224:225]
    v_mov_b64 v[254:255], v[240:241]
    v_mov_b64 v[192:193], 0
    v_mov_b64 v[194:195], 0
    v_mov_b64 v[196:197], 0
    v_mov_b64 v[198:199], 0
    v_mov_b64 v[200:201], 0
    v_mov_b64 v[202:203], 0
    v_mov_b64 v[204:205], 0
    v_mov_b64 v[206:207], 0
    v_mov_b64 v[208:209], 0
    v_mov_b64 v[210:211], 0
    v_mov_b64 v[212:213], 0
    v_mov_b64 v[214:215], 0
    v_mov_b64 v[216:217], 0
    v_mov_b64 v[218:219], 0
    v_mov_b64 v[220:221], 0
    v_mov_b64 v[222:223], 0
    s_mov_b32 s62, 0
L_slow_pv0:
    s_lshr_b32 s63, s62, 3
    s_mul_i32 s63, s63, 49152
    s_bfe_u32 s36, s62, 0x20001
    s_mul_i32 s36, s36, 5120
    s_add_u32 s63, s63, s36
    s_and_b32 s36, s62, 1
    s_lshl_b32 s37, s36, 10
    s_add_u32 s37, s37, s63
    buffer_load_dwordx4 v[44:47], v57, s[12:15], s37 offen sc1
    s_lshl_b32 s37, s36, 8
    s_add_u32 s37, s37, s63
    buffer_load_dwordx2 v[42:43], v58, s[12:15], s37 offen sc1
    s_mul_i32 s37, s36, 1280
    s_add_u32 s37, s37, s63
    s_mov_b64 exec, s[50:51]
    buffer_load_dwordx4 v[48:51], v59, s[12:15], s37 offen sc1
    buffer_load_dwordx4 v[52:55], v59, s[12:15], s37 offen offset:640 sc1
    s_mov_b64 exec, -1
    s_waitcnt vmcnt(0)
    v_mfma_f32_32x32x4_2b_bf16 v[128:159], v[42:43], v[40:41], v[224:255] cbsz:1 abid:0
    s_nop 15
    s_nop 1
    v_mfma_f32_32x32x16_bf16 v[128:143], v[44:47], v[32:35], v[128:143]
    v_mfma_f32_32x32x16_bf16 v[144:159], v[44:47], v[36:39], v[144:159]
    s_nop 11
    v_exp_f32 v128, v128
    v_exp_f32 v129, v129
    v_exp_f32 v130, v130
    v_exp_f32 v131, v131
    v_exp_f32 v132, v132
    v_exp_f32 v133, v133
    v_exp_f32 v134, v134
    v_exp_f32 v135, v135
    v_exp_f32 v136, v136
    v_exp_f32 v137, v137
    v_exp_f32 v138, v138
    v_exp_f32 v139, v139
    v_exp_f32 v140, v140
    v_exp_f32 v141, v141
    v_exp_f32 v142, v142
    v_exp_f32 v143, v143
    v_exp_f32 v144, v144
    v_exp_f32 v145, v145
    v_exp_f32 v146, v146
    v_exp_f32 v147, v147
    v_exp_f32 v148, v148
    v_exp_f32 v149, v149
    v_exp_f32 v150, v150
    v_exp_f32 v151, v151
    v_exp_f32 v152, v152
    v_exp_f32 v153, v153
    v_exp_f32 v154, v154
    v_exp_f32 v155, v155
    v_exp_f32 v156, v156
    v_exp_f32 v157, v157
    v_exp_f32 v158, v158
    v_exp_f32 v159, v159
    s_nop 1
    v_smfmac_f32_32x32x32_bf16 v[192:207], v[48:51], v[128:135], v56
    v_smfmac_f32_32x32x32_bf16 v[192:207], v[52:55], v[136:143], v56
    v_smfmac_f32_32x32x32_bf16 v[208:223], v[48:51], v[144:151], v56
    v_smfmac_f32_32x32x32_bf16 v[208:223], v[52:55], v[152:159], v56
    s_add_u32 s62, s62, 1
    s_cmp_lt_u32 s62, 64
    s_cbranch_scc1 L_slow_pv0
    v_mov_b32 v2, 0xff800000
    v_mov_b32 v3, 0xff800000
    s_mov_b32 s62, 0
L_slow_max1:
    s_lshr_b32 s63, s62, 3
    s_mul_i32 s63, s63, 49152
    s_bfe_u32 s36, s62, 0x20001
    s_mul_i32 s36, s36, 5120
    s_add_u32 s63, s63, s36
    s_and_b32 s36, s62, 1
    s_lshl_b32 s37, s36, 10
    s_add_u32 s37, s37, s63
    buffer_load_dwordx4 v[44:47], v57, s[12:15], s37 offen sc1
    s_lshl_b32 s37, s36, 8
    s_add_u32 s37, s37, s63
    buffer_load_dwordx2 v[42:43], v58, s[12:15], s37 offen sc1
    s_waitcnt vmcnt(0)
    v_mfma_f32_32x32x4_2b_bf16 v[128:159], v[42:43], v[16:17], 0 cbsz:1 abid:0
    s_nop 15
    s_nop 1
    v_mfma_f32_32x32x16_bf16 v[128:143], v[44:47], v[8:11], v[128:143]
    v_mfma_f32_32x32x16_bf16 v[144:159], v[44:47], v[12:15], v[144:159]
    s_nop 11
    v_max3_f32 v2, v2, v128, v129
    v_max3_f32 v2, v2, v130, v131
    v_max3_f32 v2, v2, v132, v133
    v_max3_f32 v2, v2, v134, v135
    v_max3_f32 v2, v2, v136, v137
    v_max3_f32 v2, v2, v138, v139
    v_max3_f32 v2, v2, v140, v141
    v_max3_f32 v2, v2, v142, v143
    v_max3_f32 v3, v3, v144, v145
    v_max3_f32 v3, v3, v146, v147
    v_max3_f32 v3, v3, v148, v149
    v_max3_f32 v3, v3, v150, v151
    v_max3_f32 v3, v3, v152, v153
    v_max3_f32 v3, v3, v154, v155
    v_max3_f32 v3, v3, v156, v157
    v_max3_f32 v3, v3, v158, v159
    s_add_u32 s62, s62, 1
    s_cmp_lt_u32 s62, 64
    s_cbranch_scc1 L_slow_max1
    v_sub_f32 v2, 0x0, v2
    v_sub_f32 v3, 0x0, v3
    v_mov_b32 v4, v2
    v_mov_b32 v5, v3
    s_nop 0
    v_permlane32_swap_b32 v2, v4
    v_permlane32_swap_b32 v3, v5
    v_min_f32 v42, v2, v4
    v_min_f32 v43, v3, v5
    v_mov_b32 v64, v42
    v_mov_b32 v65, v42
    v_mov_b32 v80, v43
    v_mov_b32 v81, v43
    v_mov_b64 v[66:67], v[64:65]
    v_mov_b64 v[82:83], v[80:81]
    v_mov_b64 v[68:69], v[64:65]
    v_mov_b64 v[84:85], v[80:81]
    v_mov_b64 v[70:71], v[64:65]
    v_mov_b64 v[86:87], v[80:81]
    v_mov_b64 v[72:73], v[64:65]
    v_mov_b64 v[88:89], v[80:81]
    v_mov_b64 v[74:75], v[64:65]
    v_mov_b64 v[90:91], v[80:81]
    v_mov_b64 v[76:77], v[64:65]
    v_mov_b64 v[92:93], v[80:81]
    v_mov_b64 v[78:79], v[64:65]
    v_mov_b64 v[94:95], v[80:81]
    v_mov_b64 v[96:97], 0
    v_mov_b64 v[98:99], 0
    v_mov_b64 v[100:101], 0
    v_mov_b64 v[102:103], 0
    v_mov_b64 v[104:105], 0
    v_mov_b64 v[106:107], 0
    v_mov_b64 v[108:109], 0
    v_mov_b64 v[110:111], 0
    v_mov_b64 v[112:113], 0
    v_mov_b64 v[114:115], 0
    v_mov_b64 v[116:117], 0
    v_mov_b64 v[118:119], 0
    v_mov_b64 v[120:121], 0
    v_mov_b64 v[122:123], 0
    v_mov_b64 v[124:125], 0
    v_mov_b64 v[126:127], 0
    s_mov_b32 s62, 0
L_slow_pv1:
    s_lshr_b32 s63, s62, 3
    s_mul_i32 s63, s63, 49152
    s_bfe_u32 s36, s62, 0x20001
    s_mul_i32 s36, s36, 5120
    s_add_u32 s63, s63, s36
    s_and_b32 s36, s62, 1
    s_lshl_b32 s37, s36, 10
    s_add_u32 s37, s37, s63
    buffer_load_dwordx4 v[44:47], v57, s[12:15], s37 offen sc1
    s_lshl_b32 s37, s36, 8
    s_add_u32 s37, s37, s63
    buffer_load_dwordx2 v[42:43], v58, s[12:15], s37 offen sc1
    s_mul_i32 s37, s36, 1280
    s_add_u32 s37, s37, s63
    s_mov_b64 exec, s[50:51]
    buffer_load_dwordx4 v[48:51], v59, s[12:15], s37 offen sc1
    buffer_load_dwordx4 v[52:55], v59, s[12:15], s37 offen offset:640 sc1
    s_mov_b64 exec, -1
    s_waitcnt vmcnt(0)
    v_mfma_f32_32x32x4_2b_bf16 v[128:159], v[42:43], v[16:17], v[64:95] cbsz:1 abid:0
    s_nop 15
    s_nop 1
    v_mfma_f32_32x32x16_bf16 v[128:143], v[44:47], v[8:11], v[128:143]
    v_mfma_f32_32x32x16_bf16 v[144:159], v[44:47], v[12:15], v[144:159]
    s_nop 11
    v_exp_f32 v128, v128
    v_exp_f32 v129, v129
    v_exp_f32 v130, v130
    v_exp_f32 v131, v131
    v_exp_f32 v132, v132
    v_exp_f32 v133, v133
    v_exp_f32 v134, v134
    v_exp_f32 v135, v135
    v_exp_f32 v136, v136
    v_exp_f32 v137, v137
    v_exp_f32 v138, v138
    v_exp_f32 v139, v139
    v_exp_f32 v140, v140
    v_exp_f32 v141, v141
    v_exp_f32 v142, v142
    v_exp_f32 v143, v143
    v_exp_f32 v144, v144
    v_exp_f32 v145, v145
    v_exp_f32 v146, v146
    v_exp_f32 v147, v147
    v_exp_f32 v148, v148
    v_exp_f32 v149, v149
    v_exp_f32 v150, v150
    v_exp_f32 v151, v151
    v_exp_f32 v152, v152
    v_exp_f32 v153, v153
    v_exp_f32 v154, v154
    v_exp_f32 v155, v155
    v_exp_f32 v156, v156
    v_exp_f32 v157, v157
    v_exp_f32 v158, v158
    v_exp_f32 v159, v159
    s_nop 1
    v_smfmac_f32_32x32x32_bf16 v[96:111], v[48:51], v[128:135], v56
    v_smfmac_f32_32x32x32_bf16 v[96:111], v[52:55], v[136:143], v56
    v_smfmac_f32_32x32x32_bf16 v[112:127], v[48:51], v[144:151], v56
    v_smfmac_f32_32x32x32_bf16 v[112:127], v[52:55], v[152:159], v56
    s_add_u32 s62, s62, 1
    s_cmp_lt_u32 s62, 64
    s_cbranch_scc1 L_slow_pv1
    s_mov_b32 s30, 1
    s_nop 11
    s_branch L_fin
.section .rodata,"a"
.p2align 6
.amdhsa_kernel concat_heads__softmax_full_mha__mha_block__prompt_kernel
  .amdhsa_next_free_vgpr 256
  .amdhsa_next_free_sgpr 102
  .amdhsa_accum_offset 256
  .amdhsa_group_segment_fixed_size 0
  .amdhsa_kernarg_size 72
  .amdhsa_user_sgpr_count 2
  .amdhsa_user_sgpr_kernarg_segment_ptr 1
  .amdhsa_system_sgpr_workgroup_id_x 1
.end_amdhsa_kernel
```
